```python
import torch

def _softmax(x, axis=-1):
    return torch.softmax(x, dim=axis)
def _gelu(x):
    return torch.nn.functional.gelu(x, approximate="tanh")
def _silu(x):
    return torch.nn.functional.silu(x)
def _sigmoid(x):
    return torch.sigmoid(x)
def _layernorm(x, axis=-1, eps=1e-5):
    m = x.mean(dim=axis, keepdim=True)
    v = x.var(dim=axis, keepdim=True, unbiased=False)
    return (x - m) / torch.sqrt(v + eps)
def _scatter_add(tgt, idx, src, axis=0):
    return tgt.clone().index_add_(axis, idx, src)
def _segment_sum(src, seg, n):
    out = torch.zeros((n,) + src.shape[1:], dtype=src.dtype)
    return out.index_add_(0, seg, src)
def _pad(x, pw):
    flat = tuple(v for pair in reversed(pw) for v in pair)
    return torch.nn.functional.pad(x, flat)

kernel_name = 'standalone__gqa_softmax__near_ridge'

def setup_inputs():

    _w = (lambda a: (lambda t: t.to(torch.bfloat16) if t.is_floating_point() else t)(torch.as_tensor(a)))
    B, Hq, Hkv, Sq, Sk, D = 16, 32, 8, 320, 320, 128
    return {
        "q": _w((lambda *s: torch.randn(*s, dtype=torch.bfloat16) * 0.8)(B, Hq, Sq, D)),
        "k": _w((lambda *s: torch.randn(*s, dtype=torch.bfloat16) * 0.8)(B, Hkv, Sk, D)),
        "v": _w((lambda *s: torch.randn(*s, dtype=torch.bfloat16) * 0.05)(B, Hkv, Sk, D)),
    }

def reference(q, k, v):
    B, Hq, Sq, D = q.shape
    Hkv = k.shape[1]
    rep = Hq // Hkv
    k = (lambda x, n, axis: torch.repeat_interleave(x, n, dim=axis))(k, rep, axis=1)
    v = (lambda x, n, axis: torch.repeat_interleave(x, n, dim=axis))(v, rep, axis=1)
    scale = D ** -0.5
    scores = torch.einsum("bhqd,bhkd->bhqk", q, k) * scale
    p = _softmax(scores, axis=-1)
    return torch.einsum("bhqk,bhkd->bhqd", p, v)
```

```asm
; @launch grid=(256,1,1) block=(512,1,1) lds=163840
.amdgcn_target "amdgcn-amd-amdhsa--gfx950"
.text
.globl standalone__gqa_softmax__near_ridge_kernel
.p2align 8
.type standalone__gqa_softmax__near_ridge_kernel,@function
standalone__gqa_softmax__near_ridge_kernel:
    s_cmp_ge_u32 s2, 256
    s_cbranch_scc1 L_end
    s_load_dwordx2 s[12:13], s[0:1], 8
    s_load_dwordx2 s[16:17], s[0:1], 16
    s_load_dwordx2 s[8:9], s[0:1], 0
    s_load_dwordx2 s[20:21], s[0:1], 24
    v_lshrrev_b32 v1, 6, v0
    v_and_b32 v205, 63, v0
    v_readfirstlane_b32 s24, v1
    s_getpc_b64 s[60:61]
L_pc:
    s_andn2_b32 s63, s2, 7
    s_lshl_b32 s63, s63, 7
    s_min_u32 s63, s63, L_end-1024-L_pc
    s_add_u32 s60, s60, s63
    s_addc_u32 s61, s61, 0
    v_and_b32 v2, 7, v205
    v_lshlrev_b32 v2, 7, v2
    s_cmp_ge_u32 s24, 1
    s_cbranch_scc1 L_noct
    global_load_dword v206, v2, s[60:61]
L_noct:
    s_and_b32 s32, s2, 7
    s_lshr_b32 s33, s2, 4
    s_lshl_b32 s33, s33, 3
    s_add_u32 s32, s32, s33
    s_mul_i32 s25, s32, 81920
    v_lshlrev_b32 v202, 4, v205
    s_mov_b32 s14, 10485760
    s_mov_b32 s15, 0x00020000
    s_mov_b32 s18, 10485760
    s_mov_b32 s19, 0x00020000
    s_mov_b32 s10, 41943040
    s_mov_b32 s11, 0x00020000
    s_lshl_b32 s44, s24, 10
    s_add_u32 s44, s44, s25
    s_add_u32 s45, s44, 8192
    s_add_u32 s46, s44, 16384
    s_add_u32 s47, s44, 24576
    v_and_b32 v2, 15, v205
    v_lshrrev_b32 v3, 4, v205
    v_lshlrev_b32 v4, 4, v2
    v_lshl_add_u32 v203, v3, 11, v4
    v_lshlrev_b32 v250, 8, v2
    v_lshl_add_u32 v250, v3, 4, v250
    s_and_b32 s35, s24, 1
    s_and_b32 s33, s24, 2
    s_sub_u32 s33, s35, s33
    s_lshl_b32 s33, s33, 13
    s_add_u32 s42, s33, s25
    s_lshl_b32 s37, s25, 2
    s_bitcmp1_b32 s2, 3
    s_cselect_b32 s33, 163840, 0
    s_add_u32 s37, s37, s33
    s_lshl_b32 s33, s24, 13
    s_add_u32 s26, s37, s33
    s_add_u32 s27, s26, 4096
    s_and_b32 s32, s24, 6
    s_cmp_lg_u32 s32, 4
    s_waitcnt lgkmcnt(0)
    buffer_load_dwordx4 v[8:11], v202, s[12:15], s44 offen nt
    buffer_load_dwordx4 v[12:15], v202, s[12:15], s45 offen nt
    buffer_load_dwordx4 v[16:19], v202, s[12:15], s46 offen nt
    buffer_load_dwordx4 v[20:23], v202, s[12:15], s47 offen nt
    s_cbranch_scc1 L_ld0
    buffer_load_dwordx4 v[64:67], v203, s[16:19], s42 offen offset:0 nt
    buffer_load_dwordx4 v[68:71], v203, s[16:19], s42 offen offset:256 nt
    buffer_load_dwordx4 v[72:75], v203, s[16:19], s42 offen offset:512 nt
    buffer_load_dwordx4 v[76:79], v203, s[16:19], s42 offen offset:768 nt
    buffer_load_dwordx4 v[80:83], v203, s[16:19], s42 offen offset:1024 nt
    buffer_load_dwordx4 v[84:87], v203, s[16:19], s42 offen offset:1280 nt
    buffer_load_dwordx4 v[88:91], v203, s[16:19], s42 offen offset:1536 nt
    buffer_load_dwordx4 v[92:95], v203, s[16:19], s42 offen offset:1792 nt
L_ld0:
    s_cmp_ge_u32 s24, 4
    s_barrier
    s_cbranch_scc1 L_ld1
    buffer_load_dwordx4 v[96:99], v250, s[8:11], s26 offen offset:0 nt
    buffer_load_dwordx4 v[100:103], v250, s[8:11], s26 offen offset:64 nt
    buffer_load_dwordx4 v[112:115], v250, s[8:11], s27 offen offset:0 nt
    buffer_load_dwordx4 v[116:119], v250, s[8:11], s27 offen offset:64 nt
    buffer_load_dwordx4 v[104:107], v250, s[8:11], s26 offen offset:128 nt
    buffer_load_dwordx4 v[108:111], v250, s[8:11], s26 offen offset:192 nt
    buffer_load_dwordx4 v[120:123], v250, s[8:11], s27 offen offset:128 nt
    buffer_load_dwordx4 v[124:127], v250, s[8:11], s27 offen offset:192 nt
L_ld1:
    s_cselect_b32 s33, 98304, 0
    s_cselect_b32 s32, 0, 49152
    s_add_u32 s39, s26, s33
    s_add_u32 s37, s37, s32
    s_add_u32 s37, s37, 32768
    s_and_b32 s32, s24, 3
    s_mul_i32 s32, s32, 12288
    s_add_u32 s37, s37, s32
    s_add_u32 s38, s37, 4096
    s_add_u32 s41, s37, 8192
    s_mov_b32 s26, s39
    s_add_u32 s27, s39, 4096
    s_mov_b32 s22, 41943040
    s_mov_b32 s23, 0x00020000
    s_mov_b32 s64, s8
    s_mov_b32 s65, s9
    s_mov_b32 s66, 0
    s_mov_b32 s67, 0x00020000
    s_mov_b32 s28, 2
    s_mov_b32 s29, 0x3e0293ee
    s_mov_b32 s30, 0x05040100
    s_mov_b32 s31, 0x07060302
    s_mov_b32 s40, 0x5d800000
    s_mov_b32 s34, 0
    s_mov_b32 s36, 0
    v_lshl_add_u32 v251, v3, 10, v4
    v_xor_b32 v5, v205, v3
    v_lshlrev_b32 v244, 4, v5
    v_xor_b32 v245, 64, v244
    v_add_u32 v246, 0x10000, v244
    v_add_u32 v247, 0x10000, v245
    v_add_u32 v248, 81920, v202
    v_add_u32 v249, 0x10000, v248
    v_and_b32 v5, 7, v2
    v_xor_b32 v5, v5, v3
    v_lshlrev_b32 v5, 4, v5
    v_lshl_add_u32 v5, v2, 8, v5
    s_lshl_b32 s33, s24, 5
    s_and_b32 s32, s33, 64
    v_xor_b32 v200, s32, v5
    s_and_b32 s33, s33, 128
    s_lshl_b32 s32, s35, 12
    s_add_u32 s33, s33, s32
    v_add_u32 v200, s33, v200
    s_lshl_b32 s33, s24, 6
    s_and_b32 s32, s33, 64
    v_xor_b32 v201, s32, v5
    s_and_b32 s33, s33, 128
    s_add_u32 s33, s33, 32768
    v_add_u32 v201, s33, v201
    s_and_b32 s33, s24, 3
    s_lshl_b32 s33, s33, 11
    s_add_u32 s62, s33, s25
    s_sub_u32 s33, s42, s25
    v_add_u32 v204, s33, v248
    v_lshrrev_b32 v5, 1, v2
    v_lshrrev_b32 v6, 1, v3
    v_cmp_eq_u32 vcc, v5, v6
    v_mov_b32 v5, 0x3f803f80
    v_and_b32 v252, 1, v2
    v_cndmask_b32 v240, 0, v5, vcc
    v_cndmask_b32 v241, 0, v5, vcc
    v_cndmask_b32 v242, 0, v5, vcc
    v_cndmask_b32 v243, 0, v5, vcc
    v_mul_u32_u24 v252, 0xaaaa, v252
    v_add_u32 v252, 0x4444, v252
    v_lshlrev_b32 v253, 4, v3
    v_mov_b32 v236, 0xff800000
    v_mov_b32 v237, 0xff800000
    s_cmp_lt_u32 s24, 6
    s_cbranch_scc1 L_c0
    s_waitcnt vmcnt(0)
L_c0:
    s_waitcnt vmcnt(11)
    v_lshlrev_b32 v192, 16, v8
    v_and_b32 v193, 0xffff0000, v8
    v_mul_f32 v192, s29, v192
    v_mul_f32 v193, s29, v193
    v_cvt_pk_bf16_f32 v8, v192, v193
    v_lshlrev_b32 v194, 16, v9
    v_and_b32 v195, 0xffff0000, v9
    v_mul_f32 v194, s29, v194
    v_mul_f32 v195, s29, v195
    v_cvt_pk_bf16_f32 v9, v194, v195
    v_lshlrev_b32 v192, 16, v10
    v_and_b32 v193, 0xffff0000, v10
    v_mul_f32 v192, s29, v192
    v_mul_f32 v193, s29, v193
    v_cvt_pk_bf16_f32 v10, v192, v193
    v_lshlrev_b32 v194, 16, v11
    v_and_b32 v195, 0xffff0000, v11
    v_mul_f32 v194, s29, v194
    v_mul_f32 v195, s29, v195
    v_cvt_pk_bf16_f32 v11, v194, v195
    ds_write_b128 v200, v[8:11] offset:0
    s_waitcnt vmcnt(10)
    v_lshlrev_b32 v192, 16, v12
    v_and_b32 v193, 0xffff0000, v12
    v_mul_f32 v192, s29, v192
    v_mul_f32 v193, s29, v193
    v_cvt_pk_bf16_f32 v12, v192, v193
    v_lshlrev_b32 v194, 16, v13
    v_and_b32 v195, 0xffff0000, v13
    v_mul_f32 v194, s29, v194
    v_mul_f32 v195, s29, v195
    v_cvt_pk_bf16_f32 v13, v194, v195
    v_lshlrev_b32 v192, 16, v14
    v_and_b32 v193, 0xffff0000, v14
    v_mul_f32 v192, s29, v192
    v_mul_f32 v193, s29, v193
    v_cvt_pk_bf16_f32 v14, v192, v193
    v_lshlrev_b32 v194, 16, v15
    v_and_b32 v195, 0xffff0000, v15
    v_mul_f32 v194, s29, v194
    v_mul_f32 v195, s29, v195
    v_cvt_pk_bf16_f32 v15, v194, v195
    ds_write_b128 v200, v[12:15] offset:8192
    s_waitcnt vmcnt(9)
    v_lshlrev_b32 v192, 16, v16
    v_and_b32 v193, 0xffff0000, v16
    v_mul_f32 v192, s29, v192
    v_mul_f32 v193, s29, v193
    v_cvt_pk_bf16_f32 v16, v192, v193
    v_lshlrev_b32 v194, 16, v17
    v_and_b32 v195, 0xffff0000, v17
    v_mul_f32 v194, s29, v194
    v_mul_f32 v195, s29, v195
    v_cvt_pk_bf16_f32 v17, v194, v195
    v_lshlrev_b32 v192, 16, v18
    v_and_b32 v193, 0xffff0000, v18
    v_mul_f32 v192, s29, v192
    v_mul_f32 v193, s29, v193
    v_cvt_pk_bf16_f32 v18, v192, v193
    v_lshlrev_b32 v194, 16, v19
    v_and_b32 v195, 0xffff0000, v19
    v_mul_f32 v194, s29, v194
    v_mul_f32 v195, s29, v195
    v_cvt_pk_bf16_f32 v19, v194, v195
    ds_write_b128 v200, v[16:19] offset:16384
    s_waitcnt vmcnt(8)
    v_lshlrev_b32 v192, 16, v20
    v_and_b32 v193, 0xffff0000, v20
    v_mul_f32 v192, s29, v192
    v_mul_f32 v193, s29, v193
    v_cvt_pk_bf16_f32 v20, v192, v193
    v_lshlrev_b32 v194, 16, v21
    v_and_b32 v195, 0xffff0000, v21
    v_mul_f32 v194, s29, v194
    v_mul_f32 v195, s29, v195
    v_cvt_pk_bf16_f32 v21, v194, v195
    v_lshlrev_b32 v192, 16, v22
    v_and_b32 v193, 0xffff0000, v22
    v_mul_f32 v192, s29, v192
    v_mul_f32 v193, s29, v193
    v_cvt_pk_bf16_f32 v22, v192, v193
    v_lshlrev_b32 v194, 16, v23
    v_and_b32 v195, 0xffff0000, v23
    v_mul_f32 v194, s29, v194
    v_mul_f32 v195, s29, v195
    v_cvt_pk_bf16_f32 v23, v194, v195
    ds_write_b128 v200, v[20:23] offset:24576
    s_cmp_ge_u32 s24, 4
    s_cbranch_scc1 L_stB
    s_mov_b64 vcc, -1
    s_waitcnt lgkmcnt(0)
    s_barrier
    s_branch L_start2
L_stB:
    s_setprio 3
    s_cmp_ge_u32 s24, 6
    s_cbranch_scc1 L_Y0
    s_waitcnt vmcnt(0)
    v_perm_b32 v176, v68, v64, s30
    v_perm_b32 v177, v76, v72, s30
    v_perm_b32 v178, v84, v80, s30
    v_perm_b32 v179, v92, v88, s30
    ds_write_b128 v204, v[176:179] offset:0
    v_perm_b32 v180, v68, v64, s31
    v_perm_b32 v181, v76, v72, s31
    v_perm_b32 v182, v84, v80, s31
    v_perm_b32 v183, v92, v88, s31
    ds_write_b128 v204, v[180:183] offset:1024
    v_perm_b32 v184, v69, v65, s30
    v_perm_b32 v185, v77, v73, s30
    v_perm_b32 v186, v85, v81, s30
    v_perm_b32 v187, v93, v89, s30
    ds_write_b128 v204, v[184:187] offset:2048
    v_perm_b32 v188, v69, v65, s31
    v_perm_b32 v189, v77, v73, s31
    v_perm_b32 v190, v85, v81, s31
    v_perm_b32 v191, v93, v89, s31
    ds_write_b128 v204, v[188:191] offset:3072
    v_perm_b32 v176, v70, v66, s30
    v_perm_b32 v177, v78, v74, s30
    v_perm_b32 v178, v86, v82, s30
    v_perm_b32 v179, v94, v90, s30
    ds_write_b128 v204, v[176:179] offset:4096
    v_perm_b32 v180, v70, v66, s31
    v_perm_b32 v181, v78, v74, s31
    v_perm_b32 v182, v86, v82, s31
    v_perm_b32 v183, v94, v90, s31
    ds_write_b128 v204, v[180:183] offset:5120
    v_perm_b32 v184, v71, v67, s30
    v_perm_b32 v185, v79, v75, s30
    v_perm_b32 v186, v87, v83, s30
    v_perm_b32 v187, v95, v91, s30
    ds_write_b128 v204, v[184:187] offset:6144
    v_perm_b32 v188, v71, v67, s31
    v_perm_b32 v189, v79, v75, s31
    v_perm_b32 v190, v87, v83, s31
    v_perm_b32 v191, v95, v91, s31
    ds_write_b128 v204, v[188:191] offset:7168
    s_waitcnt lgkmcnt(0)
    s_barrier
    s_add_u32 s33, s62, 32768
    buffer_load_dwordx4 v[24:27], v202, s[12:15], s33 offen offset:0 nt
    buffer_load_dwordx4 v[28:31], v202, s[12:15], s33 offen offset:1024 nt
    s_add_u32 s33, s62, 40960
    buffer_load_dwordx4 v[32:35], v202, s[12:15], s33 offen offset:0 nt
    buffer_load_dwordx4 v[36:39], v202, s[12:15], s33 offen offset:1024 nt
    s_add_u32 s33, s42, 32768
    buffer_load_dwordx4 v[144:147], v203, s[16:19], s33 offen offset:0 nt
    buffer_load_dwordx4 v[148:151], v203, s[16:19], s33 offen offset:256 nt
    buffer_load_dwordx4 v[152:155], v203, s[16:19], s33 offen offset:512 nt
    buffer_load_dwordx4 v[156:159], v203, s[16:19], s33 offen offset:768 nt
    buffer_load_dwordx4 v[160:163], v203, s[16:19], s33 offen offset:1024 nt
    buffer_load_dwordx4 v[164:167], v203, s[16:19], s33 offen offset:1280 nt
    buffer_load_dwordx4 v[168:171], v203, s[16:19], s33 offen offset:1536 nt
    buffer_load_dwordx4 v[172:175], v203, s[16:19], s33 offen offset:1792 nt
    s_add_u32 s33, s62, 49152
    buffer_load_dwordx4 v[40:43], v202, s[12:15], s33 offen offset:0 nt
    buffer_load_dwordx4 v[44:47], v202, s[12:15], s33 offen offset:1024 nt
    s_add_u32 s33, s62, 57344
    buffer_load_dwordx4 v[48:51], v202, s[12:15], s33 offen offset:0 nt
    buffer_load_dwordx4 v[52:55], v202, s[12:15], s33 offen offset:1024 nt
    s_waitcnt vmcnt(12)
    v_lshlrev_b32 v192, 16, v24
    v_and_b32 v193, 0xffff0000, v24
    v_mul_f32 v192, s29, v192
    v_mul_f32 v193, s29, v193
    v_cvt_pk_bf16_f32 v24, v192, v193
    v_lshlrev_b32 v194, 16, v25
    v_and_b32 v195, 0xffff0000, v25
    v_mul_f32 v194, s29, v194
    v_mul_f32 v195, s29, v195
    v_cvt_pk_bf16_f32 v25, v194, v195
    v_lshlrev_b32 v192, 16, v26
    v_and_b32 v193, 0xffff0000, v26
    v_mul_f32 v192, s29, v192
    v_mul_f32 v193, s29, v193
    v_cvt_pk_bf16_f32 v26, v192, v193
    v_lshlrev_b32 v194, 16, v27
    v_and_b32 v195, 0xffff0000, v27
    v_mul_f32 v194, s29, v194
    v_mul_f32 v195, s29, v195
    v_cvt_pk_bf16_f32 v27, v194, v195
    ds_write_b128 v201, v[24:27] offset:0
    v_lshlrev_b32 v192, 16, v28
    v_and_b32 v193, 0xffff0000, v28
    v_mul_f32 v192, s29, v192
    v_mul_f32 v193, s29, v193
    v_cvt_pk_bf16_f32 v28, v192, v193
    v_lshlrev_b32 v194, 16, v29
    v_and_b32 v195, 0xffff0000, v29
    v_mul_f32 v194, s29, v194
    v_mul_f32 v195, s29, v195
    v_cvt_pk_bf16_f32 v29, v194, v195
    v_lshlrev_b32 v192, 16, v30
    v_and_b32 v193, 0xffff0000, v30
    v_mul_f32 v192, s29, v192
    v_mul_f32 v193, s29, v193
    v_cvt_pk_bf16_f32 v30, v192, v193
    v_lshlrev_b32 v194, 16, v31
    v_and_b32 v195, 0xffff0000, v31
    v_mul_f32 v194, s29, v194
    v_mul_f32 v195, s29, v195
    v_cvt_pk_bf16_f32 v31, v194, v195
    ds_write_b128 v201, v[28:31] offset:4096
    v_lshlrev_b32 v192, 16, v32
    v_and_b32 v193, 0xffff0000, v32
    v_mul_f32 v192, s29, v192
    v_mul_f32 v193, s29, v193
    v_cvt_pk_bf16_f32 v32, v192, v193
    v_lshlrev_b32 v194, 16, v33
    v_and_b32 v195, 0xffff0000, v33
    v_mul_f32 v194, s29, v194
    v_mul_f32 v195, s29, v195
    v_cvt_pk_bf16_f32 v33, v194, v195
    v_lshlrev_b32 v192, 16, v34
    v_and_b32 v193, 0xffff0000, v34
    v_mul_f32 v192, s29, v192
    v_mul_f32 v193, s29, v193
    v_cvt_pk_bf16_f32 v34, v192, v193
    v_lshlrev_b32 v194, 16, v35
    v_and_b32 v195, 0xffff0000, v35
    v_mul_f32 v194, s29, v194
    v_mul_f32 v195, s29, v195
    v_cvt_pk_bf16_f32 v35, v194, v195
    ds_write_b128 v201, v[32:35] offset:8192
    v_lshlrev_b32 v192, 16, v36
    v_and_b32 v193, 0xffff0000, v36
    v_mul_f32 v192, s29, v192
    v_mul_f32 v193, s29, v193
    v_cvt_pk_bf16_f32 v36, v192, v193
    v_lshlrev_b32 v194, 16, v37
    v_and_b32 v195, 0xffff0000, v37
    v_mul_f32 v194, s29, v194
    v_mul_f32 v195, s29, v195
    v_cvt_pk_bf16_f32 v37, v194, v195
    v_lshlrev_b32 v192, 16, v38
    v_and_b32 v193, 0xffff0000, v38
    v_mul_f32 v192, s29, v192
    v_mul_f32 v193, s29, v193
    v_cvt_pk_bf16_f32 v38, v192, v193
    v_lshlrev_b32 v194, 16, v39
    v_and_b32 v195, 0xffff0000, v39
    v_mul_f32 v194, s29, v194
    v_mul_f32 v195, s29, v195
    v_cvt_pk_bf16_f32 v39, v194, v195
    ds_write_b128 v201, v[36:39] offset:12288
    s_add_u32 s33, s62, 65536
    buffer_load_dwordx4 v[8:11], v202, s[12:15], s33 offen offset:0 nt
    buffer_load_dwordx4 v[12:15], v202, s[12:15], s33 offen offset:1024 nt
    s_add_u32 s33, s62, 73728
    buffer_load_dwordx4 v[16:19], v202, s[12:15], s33 offen offset:0 nt
    buffer_load_dwordx4 v[20:23], v202, s[12:15], s33 offen offset:1024 nt
    s_add_u32 s33, s42, 65536
    buffer_load_dwordx4 v[64:67], v203, s[16:19], s33 offen offset:0 nt
    buffer_load_dwordx4 v[68:71], v203, s[16:19], s33 offen offset:256 nt
    buffer_load_dwordx4 v[72:75], v203, s[16:19], s33 offen offset:512 nt
    buffer_load_dwordx4 v[76:79], v203, s[16:19], s33 offen offset:768 nt
    buffer_load_dwordx4 v[80:83], v203, s[16:19], s33 offen offset:1024 nt
    buffer_load_dwordx4 v[84:87], v203, s[16:19], s33 offen offset:1280 nt
    buffer_load_dwordx4 v[88:91], v203, s[16:19], s33 offen offset:1536 nt
    buffer_load_dwordx4 v[92:95], v203, s[16:19], s33 offen offset:1792 nt
    s_waitcnt lgkmcnt(0)
    s_barrier
    s_waitcnt vmcnt(16)
    v_perm_b32 v176, v148, v144, s30
    v_perm_b32 v177, v156, v152, s30
    v_perm_b32 v178, v164, v160, s30
    v_perm_b32 v179, v172, v168, s30
    ds_write_b128 v204, v[176:179] offset:32768
    v_perm_b32 v180, v148, v144, s31
    v_perm_b32 v181, v156, v152, s31
    v_perm_b32 v182, v164, v160, s31
    v_perm_b32 v183, v172, v168, s31
    ds_write_b128 v204, v[180:183] offset:33792
    v_perm_b32 v184, v149, v145, s30
    v_perm_b32 v185, v157, v153, s30
    v_perm_b32 v186, v165, v161, s30
    v_perm_b32 v187, v173, v169, s30
    ds_write_b128 v204, v[184:187] offset:34816
    v_perm_b32 v188, v149, v145, s31
    v_perm_b32 v189, v157, v153, s31
    v_perm_b32 v190, v165, v161, s31
    v_perm_b32 v191, v173, v169, s31
    ds_write_b128 v204, v[188:191] offset:35840
    v_perm_b32 v176, v150, v146, s30
    v_perm_b32 v177, v158, v154, s30
    v_perm_b32 v178, v166, v162, s30
    v_perm_b32 v179, v174, v170, s30
    ds_write_b128 v204, v[176:179] offset:36864
    v_perm_b32 v180, v150, v146, s31
    v_perm_b32 v181, v158, v154, s31
    v_perm_b32 v182, v166, v162, s31
    v_perm_b32 v183, v174, v170, s31
    ds_write_b128 v204, v[180:183] offset:37888
    v_perm_b32 v184, v151, v147, s30
    v_perm_b32 v185, v159, v155, s30
    v_perm_b32 v186, v167, v163, s30
    v_perm_b32 v187, v175, v171, s30
    ds_write_b128 v204, v[184:187] offset:38912
    v_perm_b32 v188, v151, v147, s31
    v_perm_b32 v189, v159, v155, s31
    v_perm_b32 v190, v167, v163, s31
    v_perm_b32 v191, v175, v171, s31
    ds_write_b128 v204, v[188:191] offset:39936
    s_waitcnt vmcnt(12)
    v_lshlrev_b32 v192, 16, v40
    v_and_b32 v193, 0xffff0000, v40
    v_mul_f32 v192, s29, v192
    v_mul_f32 v193, s29, v193
    v_cvt_pk_bf16_f32 v40, v192, v193
    v_lshlrev_b32 v194, 16, v41
    v_and_b32 v195, 0xffff0000, v41
    v_mul_f32 v194, s29, v194
    v_mul_f32 v195, s29, v195
    v_cvt_pk_bf16_f32 v41, v194, v195
    v_lshlrev_b32 v192, 16, v42
    v_and_b32 v193, 0xffff0000, v42
    v_mul_f32 v192, s29, v192
    v_mul_f32 v193, s29, v193
    v_cvt_pk_bf16_f32 v42, v192, v193
    v_lshlrev_b32 v194, 16, v43
    v_and_b32 v195, 0xffff0000, v43
    v_mul_f32 v194, s29, v194
    v_mul_f32 v195, s29, v195
    v_cvt_pk_bf16_f32 v43, v194, v195
    ds_write_b128 v201, v[40:43] offset:16384
    v_lshlrev_b32 v192, 16, v44
    v_and_b32 v193, 0xffff0000, v44
    v_mul_f32 v192, s29, v192
    v_mul_f32 v193, s29, v193
    v_cvt_pk_bf16_f32 v44, v192, v193
    v_lshlrev_b32 v194, 16, v45
    v_and_b32 v195, 0xffff0000, v45
    v_mul_f32 v194, s29, v194
    v_mul_f32 v195, s29, v195
    v_cvt_pk_bf16_f32 v45, v194, v195
    v_lshlrev_b32 v192, 16, v46
    v_and_b32 v193, 0xffff0000, v46
    v_mul_f32 v192, s29, v192
    v_mul_f32 v193, s29, v193
    v_cvt_pk_bf16_f32 v46, v192, v193
    v_lshlrev_b32 v194, 16, v47
    v_and_b32 v195, 0xffff0000, v47
    v_mul_f32 v194, s29, v194
    v_mul_f32 v195, s29, v195
    v_cvt_pk_bf16_f32 v47, v194, v195
    ds_write_b128 v201, v[44:47] offset:20480
    v_lshlrev_b32 v192, 16, v48
    v_and_b32 v193, 0xffff0000, v48
    v_mul_f32 v192, s29, v192
    v_mul_f32 v193, s29, v193
    v_cvt_pk_bf16_f32 v48, v192, v193
    v_lshlrev_b32 v194, 16, v49
    v_and_b32 v195, 0xffff0000, v49
    v_mul_f32 v194, s29, v194
    v_mul_f32 v195, s29, v195
    v_cvt_pk_bf16_f32 v49, v194, v195
    v_lshlrev_b32 v192, 16, v50
    v_and_b32 v193, 0xffff0000, v50
    v_mul_f32 v192, s29, v192
    v_mul_f32 v193, s29, v193
    v_cvt_pk_bf16_f32 v50, v192, v193
    v_lshlrev_b32 v194, 16, v51
    v_and_b32 v195, 0xffff0000, v51
    v_mul_f32 v194, s29, v194
    v_mul_f32 v195, s29, v195
    v_cvt_pk_bf16_f32 v51, v194, v195
    ds_write_b128 v201, v[48:51] offset:24576
    v_lshlrev_b32 v192, 16, v52
    v_and_b32 v193, 0xffff0000, v52
    v_mul_f32 v192, s29, v192
    v_mul_f32 v193, s29, v193
    v_cvt_pk_bf16_f32 v52, v192, v193
    v_lshlrev_b32 v194, 16, v53
    v_and_b32 v195, 0xffff0000, v53
    v_mul_f32 v194, s29, v194
    v_mul_f32 v195, s29, v195
    v_cvt_pk_bf16_f32 v53, v194, v195
    v_lshlrev_b32 v192, 16, v54
    v_and_b32 v193, 0xffff0000, v54
    v_mul_f32 v192, s29, v192
    v_mul_f32 v193, s29, v193
    v_cvt_pk_bf16_f32 v54, v192, v193
    v_lshlrev_b32 v194, 16, v55
    v_and_b32 v195, 0xffff0000, v55
    v_mul_f32 v194, s29, v194
    v_mul_f32 v195, s29, v195
    v_cvt_pk_bf16_f32 v55, v194, v195
    ds_write_b128 v201, v[52:55] offset:28672
    s_waitcnt lgkmcnt(0)
    s_barrier
    s_waitcnt vmcnt(8)
    v_lshlrev_b32 v192, 16, v8
    v_and_b32 v193, 0xffff0000, v8
    v_mul_f32 v192, s29, v192
    v_mul_f32 v193, s29, v193
    v_cvt_pk_bf16_f32 v8, v192, v193
    v_lshlrev_b32 v194, 16, v9
    v_and_b32 v195, 0xffff0000, v9
    v_mul_f32 v194, s29, v194
    v_mul_f32 v195, s29, v195
    v_cvt_pk_bf16_f32 v9, v194, v195
    v_lshlrev_b32 v192, 16, v10
    v_and_b32 v193, 0xffff0000, v10
    v_mul_f32 v192, s29, v192
    v_mul_f32 v193, s29, v193
    v_cvt_pk_bf16_f32 v10, v192, v193
    v_lshlrev_b32 v194, 16, v11
    v_and_b32 v195, 0xffff0000, v11
    v_mul_f32 v194, s29, v194
    v_mul_f32 v195, s29, v195
    v_cvt_pk_bf16_f32 v11, v194, v195
    ds_write_b128 v201, v[8:11] offset:32768
    v_lshlrev_b32 v192, 16, v12
    v_and_b32 v193, 0xffff0000, v12
    v_mul_f32 v192, s29, v192
    v_mul_f32 v193, s29, v193
    v_cvt_pk_bf16_f32 v12, v192, v193
    v_lshlrev_b32 v194, 16, v13
    v_and_b32 v195, 0xffff0000, v13
    v_mul_f32 v194, s29, v194
    v_mul_f32 v195, s29, v195
    v_cvt_pk_bf16_f32 v13, v194, v195
    v_lshlrev_b32 v192, 16, v14
    v_and_b32 v193, 0xffff0000, v14
    v_mul_f32 v192, s29, v192
    v_mul_f32 v193, s29, v193
    v_cvt_pk_bf16_f32 v14, v192, v193
    v_lshlrev_b32 v194, 16, v15
    v_and_b32 v195, 0xffff0000, v15
    v_mul_f32 v194, s29, v194
    v_mul_f32 v195, s29, v195
    v_cvt_pk_bf16_f32 v15, v194, v195
    ds_write_b128 v201, v[12:15] offset:36864
    v_lshlrev_b32 v192, 16, v16
    v_and_b32 v193, 0xffff0000, v16
    v_mul_f32 v192, s29, v192
    v_mul_f32 v193, s29, v193
    v_cvt_pk_bf16_f32 v16, v192, v193
    v_lshlrev_b32 v194, 16, v17
    v_and_b32 v195, 0xffff0000, v17
    v_mul_f32 v194, s29, v194
    v_mul_f32 v195, s29, v195
    v_cvt_pk_bf16_f32 v17, v194, v195
    v_lshlrev_b32 v192, 16, v18
    v_and_b32 v193, 0xffff0000, v18
    v_mul_f32 v192, s29, v192
    v_mul_f32 v193, s29, v193
    v_cvt_pk_bf16_f32 v18, v192, v193
    v_lshlrev_b32 v194, 16, v19
    v_and_b32 v195, 0xffff0000, v19
    v_mul_f32 v194, s29, v194
    v_mul_f32 v195, s29, v195
    v_cvt_pk_bf16_f32 v19, v194, v195
    ds_write_b128 v201, v[16:19] offset:40960
    v_lshlrev_b32 v192, 16, v20
    v_and_b32 v193, 0xffff0000, v20
    v_mul_f32 v192, s29, v192
    v_mul_f32 v193, s29, v193
    v_cvt_pk_bf16_f32 v20, v192, v193
    v_lshlrev_b32 v194, 16, v21
    v_and_b32 v195, 0xffff0000, v21
    v_mul_f32 v194, s29, v194
    v_mul_f32 v195, s29, v195
    v_cvt_pk_bf16_f32 v21, v194, v195
    v_lshlrev_b32 v192, 16, v22
    v_and_b32 v193, 0xffff0000, v22
    v_mul_f32 v192, s29, v192
    v_mul_f32 v193, s29, v193
    v_cvt_pk_bf16_f32 v22, v192, v193
    v_lshlrev_b32 v194, 16, v23
    v_and_b32 v195, 0xffff0000, v23
    v_mul_f32 v194, s29, v194
    v_mul_f32 v195, s29, v195
    v_cvt_pk_bf16_f32 v23, v194, v195
    ds_write_b128 v201, v[20:23] offset:45056
    buffer_load_dwordx4 v[96:99], v250, s[8:11], s37 offen offset:0 nt
    buffer_load_dwordx4 v[100:103], v250, s[8:11], s37 offen offset:64 nt
    buffer_load_dwordx4 v[112:115], v250, s[8:11], s38 offen offset:0 nt
    buffer_load_dwordx4 v[116:119], v250, s[8:11], s38 offen offset:64 nt
    buffer_load_dwordx4 v[128:131], v250, s[8:11], s41 offen offset:0 nt
    buffer_load_dwordx4 v[132:135], v250, s[8:11], s41 offen offset:64 nt
    buffer_load_dwordx4 v[104:107], v250, s[8:11], s37 offen offset:128 nt
    buffer_load_dwordx4 v[108:111], v250, s[8:11], s37 offen offset:192 nt
    buffer_load_dwordx4 v[120:123], v250, s[8:11], s38 offen offset:128 nt
    buffer_load_dwordx4 v[124:127], v250, s[8:11], s38 offen offset:192 nt
    buffer_load_dwordx4 v[136:139], v250, s[8:11], s41 offen offset:128 nt
    buffer_load_dwordx4 v[140:143], v250, s[8:11], s41 offen offset:192 nt
    s_waitcnt vmcnt(12)
    v_add_u32 v204, 0x8000, v204
    v_perm_b32 v176, v68, v64, s30
    v_perm_b32 v177, v76, v72, s30
    v_perm_b32 v178, v84, v80, s30
    v_perm_b32 v179, v92, v88, s30
    ds_write_b128 v204, v[176:179] offset:32768
    v_perm_b32 v180, v68, v64, s31
    v_perm_b32 v181, v76, v72, s31
    v_perm_b32 v182, v84, v80, s31
    v_perm_b32 v183, v92, v88, s31
    ds_write_b128 v204, v[180:183] offset:33792
    v_perm_b32 v184, v69, v65, s30
    v_perm_b32 v185, v77, v73, s30
    v_perm_b32 v186, v85, v81, s30
    v_perm_b32 v187, v93, v89, s30
    ds_write_b128 v204, v[184:187] offset:34816
    v_perm_b32 v188, v69, v65, s31
    v_perm_b32 v189, v77, v73, s31
    v_perm_b32 v190, v85, v81, s31
    v_perm_b32 v191, v93, v89, s31
    ds_write_b128 v204, v[188:191] offset:35840
    v_perm_b32 v176, v70, v66, s30
    v_perm_b32 v177, v78, v74, s30
    v_perm_b32 v178, v86, v82, s30
    v_perm_b32 v179, v94, v90, s30
    ds_write_b128 v204, v[176:179] offset:36864
    v_perm_b32 v180, v70, v66, s31
    v_perm_b32 v181, v78, v74, s31
    v_perm_b32 v182, v86, v82, s31
    v_perm_b32 v183, v94, v90, s31
    ds_write_b128 v204, v[180:183] offset:37888
    v_perm_b32 v184, v71, v67, s30
    v_perm_b32 v185, v79, v75, s30
    v_perm_b32 v186, v87, v83, s30
    v_perm_b32 v187, v95, v91, s30
    ds_write_b128 v204, v[184:187] offset:38912
    v_perm_b32 v188, v71, v67, s31
    v_perm_b32 v189, v79, v75, s31
    v_perm_b32 v190, v87, v83, s31
    v_perm_b32 v191, v95, v91, s31
    ds_write_b128 v204, v[188:191] offset:39936
    s_branch L_stE
L_Y0:
    s_waitcnt lgkmcnt(0)
    s_barrier
    s_add_u32 s33, s42, 32768
    buffer_load_dwordx4 v[144:147], v203, s[16:19], s33 offen offset:0 nt
    buffer_load_dwordx4 v[148:151], v203, s[16:19], s33 offen offset:256 nt
    buffer_load_dwordx4 v[152:155], v203, s[16:19], s33 offen offset:512 nt
    buffer_load_dwordx4 v[156:159], v203, s[16:19], s33 offen offset:768 nt
    buffer_load_dwordx4 v[160:163], v203, s[16:19], s33 offen offset:1024 nt
    buffer_load_dwordx4 v[164:167], v203, s[16:19], s33 offen offset:1280 nt
    buffer_load_dwordx4 v[168:171], v203, s[16:19], s33 offen offset:1536 nt
    buffer_load_dwordx4 v[172:175], v203, s[16:19], s33 offen offset:1792 nt
    s_add_u32 s33, s62, 32768
    buffer_load_dwordx4 v[24:27], v202, s[12:15], s33 offen offset:0 nt
    buffer_load_dwordx4 v[28:31], v202, s[12:15], s33 offen offset:1024 nt
    s_add_u32 s33, s62, 40960
    buffer_load_dwordx4 v[32:35], v202, s[12:15], s33 offen offset:0 nt
    buffer_load_dwordx4 v[36:39], v202, s[12:15], s33 offen offset:1024 nt
    s_waitcnt vmcnt(4)
    s_add_u32 s33, s62, 49152
    buffer_load_dwordx4 v[40:43], v202, s[12:15], s33 offen offset:0 nt
    v_perm_b32 v176, v148, v144, s30
    v_perm_b32 v177, v156, v152, s30
    v_perm_b32 v178, v164, v160, s30
    v_perm_b32 v179, v172, v168, s30
    ds_write_b128 v204, v[176:179] offset:32768
    v_perm_b32 v180, v148, v144, s31
    v_perm_b32 v181, v156, v152, s31
    v_perm_b32 v182, v164, v160, s31
    v_perm_b32 v183, v172, v168, s31
    ds_write_b128 v204, v[180:183] offset:33792
    buffer_load_dwordx4 v[44:47], v202, s[12:15], s33 offen offset:1024 nt
    v_perm_b32 v184, v149, v145, s30
    v_perm_b32 v185, v157, v153, s30
    v_perm_b32 v186, v165, v161, s30
    v_perm_b32 v187, v173, v169, s30
    ds_write_b128 v204, v[184:187] offset:34816
    v_perm_b32 v188, v149, v145, s31
    v_perm_b32 v189, v157, v153, s31
    v_perm_b32 v190, v165, v161, s31
    v_perm_b32 v191, v173, v169, s31
    ds_write_b128 v204, v[188:191] offset:35840
    s_add_u32 s33, s62, 57344
    buffer_load_dwordx4 v[48:51], v202, s[12:15], s33 offen offset:0 nt
    v_perm_b32 v176, v150, v146, s30
    v_perm_b32 v177, v158, v154, s30
    v_perm_b32 v178, v166, v162, s30
    v_perm_b32 v179, v174, v170, s30
    ds_write_b128 v204, v[176:179] offset:36864
    v_perm_b32 v180, v150, v146, s31
    v_perm_b32 v181, v158, v154, s31
    v_perm_b32 v182, v166, v162, s31
    v_perm_b32 v183, v174, v170, s31
    ds_write_b128 v204, v[180:183] offset:37888
    buffer_load_dwordx4 v[52:55], v202, s[12:15], s33 offen offset:1024 nt
    v_perm_b32 v184, v151, v147, s30
    v_perm_b32 v185, v159, v155, s30
    v_perm_b32 v186, v167, v163, s30
    v_perm_b32 v187, v175, v171, s30
    ds_write_b128 v204, v[184:187] offset:38912
    v_perm_b32 v188, v151, v147, s31
    v_perm_b32 v189, v159, v155, s31
    v_perm_b32 v190, v167, v163, s31
    v_perm_b32 v191, v175, v171, s31
    ds_write_b128 v204, v[188:191] offset:39936
    s_waitcnt vmcnt(4)
    v_lshlrev_b32 v192, 16, v24
    v_and_b32 v193, 0xffff0000, v24
    v_mul_f32 v192, s29, v192
    v_mul_f32 v193, s29, v193
    v_cvt_pk_bf16_f32 v24, v192, v193
    v_lshlrev_b32 v194, 16, v25
    v_and_b32 v195, 0xffff0000, v25
    v_mul_f32 v194, s29, v194
    v_mul_f32 v195, s29, v195
    v_cvt_pk_bf16_f32 v25, v194, v195
    v_lshlrev_b32 v192, 16, v26
    v_and_b32 v193, 0xffff0000, v26
    v_mul_f32 v192, s29, v192
    v_mul_f32 v193, s29, v193
    v_cvt_pk_bf16_f32 v26, v192, v193
    v_lshlrev_b32 v194, 16, v27
    v_and_b32 v195, 0xffff0000, v27
    v_mul_f32 v194, s29, v194
    v_mul_f32 v195, s29, v195
    v_cvt_pk_bf16_f32 v27, v194, v195
    ds_write_b128 v201, v[24:27] offset:0
    v_lshlrev_b32 v192, 16, v28
    v_and_b32 v193, 0xffff0000, v28
    v_mul_f32 v192, s29, v192
    v_mul_f32 v193, s29, v193
    v_cvt_pk_bf16_f32 v28, v192, v193
    v_lshlrev_b32 v194, 16, v29
    v_and_b32 v195, 0xffff0000, v29
    v_mul_f32 v194, s29, v194
    v_mul_f32 v195, s29, v195
    v_cvt_pk_bf16_f32 v29, v194, v195
    v_lshlrev_b32 v192, 16, v30
    v_and_b32 v193, 0xffff0000, v30
    v_mul_f32 v192, s29, v192
    v_mul_f32 v193, s29, v193
    v_cvt_pk_bf16_f32 v30, v192, v193
    v_lshlrev_b32 v194, 16, v31
    v_and_b32 v195, 0xffff0000, v31
    v_mul_f32 v194, s29, v194
    v_mul_f32 v195, s29, v195
    v_cvt_pk_bf16_f32 v31, v194, v195
    ds_write_b128 v201, v[28:31] offset:4096
    v_lshlrev_b32 v192, 16, v32
    v_and_b32 v193, 0xffff0000, v32
    v_mul_f32 v192, s29, v192
    v_mul_f32 v193, s29, v193
    v_cvt_pk_bf16_f32 v32, v192, v193
    v_lshlrev_b32 v194, 16, v33
    v_and_b32 v195, 0xffff0000, v33
    v_mul_f32 v194, s29, v194
    v_mul_f32 v195, s29, v195
    v_cvt_pk_bf16_f32 v33, v194, v195
    v_lshlrev_b32 v192, 16, v34
    v_and_b32 v193, 0xffff0000, v34
    v_mul_f32 v192, s29, v192
    v_mul_f32 v193, s29, v193
    v_cvt_pk_bf16_f32 v34, v192, v193
    v_lshlrev_b32 v194, 16, v35
    v_and_b32 v195, 0xffff0000, v35
    v_mul_f32 v194, s29, v194
    v_mul_f32 v195, s29, v195
    v_cvt_pk_bf16_f32 v35, v194, v195
    ds_write_b128 v201, v[32:35] offset:8192
    v_lshlrev_b32 v192, 16, v36
    v_and_b32 v193, 0xffff0000, v36
    v_mul_f32 v192, s29, v192
    v_mul_f32 v193, s29, v193
    v_cvt_pk_bf16_f32 v36, v192, v193
    v_lshlrev_b32 v194, 16, v37
    v_and_b32 v195, 0xffff0000, v37
    v_mul_f32 v194, s29, v194
    v_mul_f32 v195, s29, v195
    v_cvt_pk_bf16_f32 v37, v194, v195
    v_lshlrev_b32 v192, 16, v38
    v_and_b32 v193, 0xffff0000, v38
    v_mul_f32 v192, s29, v192
    v_mul_f32 v193, s29, v193
    v_cvt_pk_bf16_f32 v38, v192, v193
    v_lshlrev_b32 v194, 16, v39
    v_and_b32 v195, 0xffff0000, v39
    v_mul_f32 v194, s29, v194
    v_mul_f32 v195, s29, v195
    v_cvt_pk_bf16_f32 v39, v194, v195
    ds_write_b128 v201, v[36:39] offset:12288
    s_waitcnt lgkmcnt(0)
    s_barrier
    s_add_u32 s33, s42, 65536
    buffer_load_dwordx4 v[64:67], v203, s[16:19], s33 offen offset:0 nt
    buffer_load_dwordx4 v[68:71], v203, s[16:19], s33 offen offset:256 nt
    buffer_load_dwordx4 v[72:75], v203, s[16:19], s33 offen offset:512 nt
    buffer_load_dwordx4 v[76:79], v203, s[16:19], s33 offen offset:768 nt
    buffer_load_dwordx4 v[80:83], v203, s[16:19], s33 offen offset:1024 nt
    buffer_load_dwordx4 v[84:87], v203, s[16:19], s33 offen offset:1280 nt
    buffer_load_dwordx4 v[88:91], v203, s[16:19], s33 offen offset:1536 nt
    buffer_load_dwordx4 v[92:95], v203, s[16:19], s33 offen offset:1792 nt
    s_add_u32 s33, s62, 65536
    buffer_load_dwordx4 v[8:11], v202, s[12:15], s33 offen offset:0 nt
    buffer_load_dwordx4 v[12:15], v202, s[12:15], s33 offen offset:1024 nt
    s_add_u32 s33, s62, 73728
    buffer_load_dwordx4 v[16:19], v202, s[12:15], s33 offen offset:0 nt
    buffer_load_dwordx4 v[20:23], v202, s[12:15], s33 offen offset:1024 nt
    s_waitcnt vmcnt(12)
    v_lshlrev_b32 v192, 16, v40
    v_and_b32 v193, 0xffff0000, v40
    v_mul_f32 v192, s29, v192
    v_mul_f32 v193, s29, v193
    v_cvt_pk_bf16_f32 v40, v192, v193
    v_lshlrev_b32 v194, 16, v41
    v_and_b32 v195, 0xffff0000, v41
    v_mul_f32 v194, s29, v194
    v_mul_f32 v195, s29, v195
    v_cvt_pk_bf16_f32 v41, v194, v195
    v_lshlrev_b32 v192, 16, v42
    v_and_b32 v193, 0xffff0000, v42
    v_mul_f32 v192, s29, v192
    v_mul_f32 v193, s29, v193
    v_cvt_pk_bf16_f32 v42, v192, v193
    v_lshlrev_b32 v194, 16, v43
    v_and_b32 v195, 0xffff0000, v43
    v_mul_f32 v194, s29, v194
    v_mul_f32 v195, s29, v195
    v_cvt_pk_bf16_f32 v43, v194, v195
    ds_write_b128 v201, v[40:43] offset:16384
    v_lshlrev_b32 v192, 16, v44
    v_and_b32 v193, 0xffff0000, v44
    v_mul_f32 v192, s29, v192
    v_mul_f32 v193, s29, v193
    v_cvt_pk_bf16_f32 v44, v192, v193
    v_lshlrev_b32 v194, 16, v45
    v_and_b32 v195, 0xffff0000, v45
    v_mul_f32 v194, s29, v194
    v_mul_f32 v195, s29, v195
    v_cvt_pk_bf16_f32 v45, v194, v195
    v_lshlrev_b32 v192, 16, v46
    v_and_b32 v193, 0xffff0000, v46
    v_mul_f32 v192, s29, v192
    v_mul_f32 v193, s29, v193
    v_cvt_pk_bf16_f32 v46, v192, v193
    v_lshlrev_b32 v194, 16, v47
    v_and_b32 v195, 0xffff0000, v47
    v_mul_f32 v194, s29, v194
    v_mul_f32 v195, s29, v195
    v_cvt_pk_bf16_f32 v47, v194, v195
    ds_write_b128 v201, v[44:47] offset:20480
    v_lshlrev_b32 v192, 16, v48
    v_and_b32 v193, 0xffff0000, v48
    v_mul_f32 v192, s29, v192
    v_mul_f32 v193, s29, v193
    v_cvt_pk_bf16_f32 v48, v192, v193
    v_lshlrev_b32 v194, 16, v49
    v_and_b32 v195, 0xffff0000, v49
    v_mul_f32 v194, s29, v194
    v_mul_f32 v195, s29, v195
    v_cvt_pk_bf16_f32 v49, v194, v195
    v_lshlrev_b32 v192, 16, v50
    v_and_b32 v193, 0xffff0000, v50
    v_mul_f32 v192, s29, v192
    v_mul_f32 v193, s29, v193
    v_cvt_pk_bf16_f32 v50, v192, v193
    v_lshlrev_b32 v194, 16, v51
    v_and_b32 v195, 0xffff0000, v51
    v_mul_f32 v194, s29, v194
    v_mul_f32 v195, s29, v195
    v_cvt_pk_bf16_f32 v51, v194, v195
    ds_write_b128 v201, v[48:51] offset:24576
    v_lshlrev_b32 v192, 16, v52
    v_and_b32 v193, 0xffff0000, v52
    v_mul_f32 v192, s29, v192
    v_mul_f32 v193, s29, v193
    v_cvt_pk_bf16_f32 v52, v192, v193
    v_lshlrev_b32 v194, 16, v53
    v_and_b32 v195, 0xffff0000, v53
    v_mul_f32 v194, s29, v194
    v_mul_f32 v195, s29, v195
    v_cvt_pk_bf16_f32 v53, v194, v195
    v_lshlrev_b32 v192, 16, v54
    v_and_b32 v193, 0xffff0000, v54
    v_mul_f32 v192, s29, v192
    v_mul_f32 v193, s29, v193
    v_cvt_pk_bf16_f32 v54, v192, v193
    v_lshlrev_b32 v194, 16, v55
    v_and_b32 v195, 0xffff0000, v55
    v_mul_f32 v194, s29, v194
    v_mul_f32 v195, s29, v195
    v_cvt_pk_bf16_f32 v55, v194, v195
    ds_write_b128 v201, v[52:55] offset:28672
    buffer_load_dwordx4 v[96:99], v250, s[8:11], s37 offen offset:0 nt
    buffer_load_dwordx4 v[100:103], v250, s[8:11], s37 offen offset:64 nt
    buffer_load_dwordx4 v[112:115], v250, s[8:11], s38 offen offset:0 nt
    buffer_load_dwordx4 v[116:119], v250, s[8:11], s38 offen offset:64 nt
    buffer_load_dwordx4 v[128:131], v250, s[8:11], s41 offen offset:0 nt
    buffer_load_dwordx4 v[132:135], v250, s[8:11], s41 offen offset:64 nt
    buffer_load_dwordx4 v[104:107], v250, s[8:11], s37 offen offset:128 nt
    buffer_load_dwordx4 v[108:111], v250, s[8:11], s37 offen offset:192 nt
    buffer_load_dwordx4 v[120:123], v250, s[8:11], s38 offen offset:128 nt
    buffer_load_dwordx4 v[124:127], v250, s[8:11], s38 offen offset:192 nt
    buffer_load_dwordx4 v[136:139], v250, s[8:11], s41 offen offset:128 nt
    buffer_load_dwordx4 v[140:143], v250, s[8:11], s41 offen offset:192 nt
    s_waitcnt lgkmcnt(0)
    s_barrier
    s_waitcnt vmcnt(16)
    v_add_u32 v204, 0x8000, v204
    v_perm_b32 v176, v68, v64, s30
    v_perm_b32 v177, v76, v72, s30
    v_perm_b32 v178, v84, v80, s30
    v_perm_b32 v179, v92, v88, s30
    ds_write_b128 v204, v[176:179] offset:32768
    v_perm_b32 v180, v68, v64, s31
    v_perm_b32 v181, v76, v72, s31
    v_perm_b32 v182, v84, v80, s31
    v_perm_b32 v183, v92, v88, s31
    ds_write_b128 v204, v[180:183] offset:33792
    v_perm_b32 v184, v69, v65, s30
    v_perm_b32 v185, v77, v73, s30
    v_perm_b32 v186, v85, v81, s30
    v_perm_b32 v187, v93, v89, s30
    ds_write_b128 v204, v[184:187] offset:34816
    v_perm_b32 v188, v69, v65, s31
    v_perm_b32 v189, v77, v73, s31
    v_perm_b32 v190, v85, v81, s31
    v_perm_b32 v191, v93, v89, s31
    ds_write_b128 v204, v[188:191] offset:35840
    v_perm_b32 v176, v70, v66, s30
    v_perm_b32 v177, v78, v74, s30
    v_perm_b32 v178, v86, v82, s30
    v_perm_b32 v179, v94, v90, s30
    ds_write_b128 v204, v[176:179] offset:36864
    v_perm_b32 v180, v70, v66, s31
    v_perm_b32 v181, v78, v74, s31
    v_perm_b32 v182, v86, v82, s31
    v_perm_b32 v183, v94, v90, s31
    ds_write_b128 v204, v[180:183] offset:37888
    v_perm_b32 v184, v71, v67, s30
    v_perm_b32 v185, v79, v75, s30
    v_perm_b32 v186, v87, v83, s30
    v_perm_b32 v187, v95, v91, s30
    ds_write_b128 v204, v[184:187] offset:38912
    v_perm_b32 v188, v71, v67, s31
    v_perm_b32 v189, v79, v75, s31
    v_perm_b32 v190, v87, v83, s31
    v_perm_b32 v191, v95, v91, s31
    ds_write_b128 v204, v[188:191] offset:39936
    s_waitcnt vmcnt(12)
    v_lshlrev_b32 v192, 16, v8
    v_and_b32 v193, 0xffff0000, v8
    v_mul_f32 v192, s29, v192
    v_mul_f32 v193, s29, v193
    v_cvt_pk_bf16_f32 v8, v192, v193
    v_lshlrev_b32 v194, 16, v9
    v_and_b32 v195, 0xffff0000, v9
    v_mul_f32 v194, s29, v194
    v_mul_f32 v195, s29, v195
    v_cvt_pk_bf16_f32 v9, v194, v195
    v_lshlrev_b32 v192, 16, v10
    v_and_b32 v193, 0xffff0000, v10
    v_mul_f32 v192, s29, v192
    v_mul_f32 v193, s29, v193
    v_cvt_pk_bf16_f32 v10, v192, v193
    v_lshlrev_b32 v194, 16, v11
    v_and_b32 v195, 0xffff0000, v11
    v_mul_f32 v194, s29, v194
    v_mul_f32 v195, s29, v195
    v_cvt_pk_bf16_f32 v11, v194, v195
    ds_write_b128 v201, v[8:11] offset:32768
    v_lshlrev_b32 v192, 16, v12
    v_and_b32 v193, 0xffff0000, v12
    v_mul_f32 v192, s29, v192
    v_mul_f32 v193, s29, v193
    v_cvt_pk_bf16_f32 v12, v192, v193
    v_lshlrev_b32 v194, 16, v13
    v_and_b32 v195, 0xffff0000, v13
    v_mul_f32 v194, s29, v194
    v_mul_f32 v195, s29, v195
    v_cvt_pk_bf16_f32 v13, v194, v195
    v_lshlrev_b32 v192, 16, v14
    v_and_b32 v193, 0xffff0000, v14
    v_mul_f32 v192, s29, v192
    v_mul_f32 v193, s29, v193
    v_cvt_pk_bf16_f32 v14, v192, v193
    v_lshlrev_b32 v194, 16, v15
    v_and_b32 v195, 0xffff0000, v15
    v_mul_f32 v194, s29, v194
    v_mul_f32 v195, s29, v195
    v_cvt_pk_bf16_f32 v15, v194, v195
    ds_write_b128 v201, v[12:15] offset:36864
    v_lshlrev_b32 v192, 16, v16
    v_and_b32 v193, 0xffff0000, v16
    v_mul_f32 v192, s29, v192
    v_mul_f32 v193, s29, v193
    v_cvt_pk_bf16_f32 v16, v192, v193
    v_lshlrev_b32 v194, 16, v17
    v_and_b32 v195, 0xffff0000, v17
    v_mul_f32 v194, s29, v194
    v_mul_f32 v195, s29, v195
    v_cvt_pk_bf16_f32 v17, v194, v195
    v_lshlrev_b32 v192, 16, v18
    v_and_b32 v193, 0xffff0000, v18
    v_mul_f32 v192, s29, v192
    v_mul_f32 v193, s29, v193
    v_cvt_pk_bf16_f32 v18, v192, v193
    v_lshlrev_b32 v194, 16, v19
    v_and_b32 v195, 0xffff0000, v19
    v_mul_f32 v194, s29, v194
    v_mul_f32 v195, s29, v195
    v_cvt_pk_bf16_f32 v19, v194, v195
    ds_write_b128 v201, v[16:19] offset:40960
    v_lshlrev_b32 v192, 16, v20
    v_and_b32 v193, 0xffff0000, v20
    v_mul_f32 v192, s29, v192
    v_mul_f32 v193, s29, v193
    v_cvt_pk_bf16_f32 v20, v192, v193
    v_lshlrev_b32 v194, 16, v21
    v_and_b32 v195, 0xffff0000, v21
    v_mul_f32 v194, s29, v194
    v_mul_f32 v195, s29, v195
    v_cvt_pk_bf16_f32 v21, v194, v195
    v_lshlrev_b32 v192, 16, v22
    v_and_b32 v193, 0xffff0000, v22
    v_mul_f32 v192, s29, v192
    v_mul_f32 v193, s29, v193
    v_cvt_pk_bf16_f32 v22, v192, v193
    v_lshlrev_b32 v194, 16, v23
    v_and_b32 v195, 0xffff0000, v23
    v_mul_f32 v194, s29, v194
    v_mul_f32 v195, s29, v195
    v_cvt_pk_bf16_f32 v23, v194, v195
    ds_write_b128 v201, v[20:23] offset:45056
L_stE:
    s_waitcnt lgkmcnt(0)
    s_barrier
L_stF:
    s_mov_b64 vcc, 0
L_start3:
    ds_read_b128 v[200:203], v244 offset:0
    ds_read_b128 v[204:207], v245 offset:1024
    ds_read_b128 v[208:211], v244 offset:2048
    ds_read_b128 v[212:215], v245 offset:3072
    ds_read_b128 v[216:219], v244 offset:4096
    s_waitcnt vmcnt(0)
L_body3:
    s_cmp_le_u32 s28, 1
    s_cselect_b32 s66, 0, 41943040
    s_setprio 3
    s_waitcnt lgkmcnt(3)
    v_mfma_f32_16x16x32_bf16 v[144:147], v[200:203], v[96:99], 0
    v_mfma_f32_16x16x32_bf16 v[144:147], v[204:207], v[100:103], v[144:147]
    v_mfma_f32_16x16x32_bf16 v[148:151], v[200:203], v[112:115], 0
    v_mfma_f32_16x16x32_bf16 v[148:151], v[204:207], v[116:119], v[148:151]
    v_mfma_f32_16x16x32_bf16 v[152:155], v[200:203], v[128:131], 0
    ds_read_b128 v[200:203], v245 offset:5120
    v_mfma_f32_16x16x32_bf16 v[152:155], v[204:207], v[132:135], v[152:155]
    ds_read_b128 v[204:207], v244 offset:6144
    s_waitcnt lgkmcnt(3)
    v_mfma_f32_16x16x32_bf16 v[152:155], v[208:211], v[136:139], v[152:155]
    v_mfma_f32_16x16x32_bf16 v[152:155], v[212:215], v[140:143], v[152:155]
    v_mfma_f32_16x16x32_bf16 v[148:151], v[208:211], v[120:123], v[148:151]
    v_mfma_f32_16x16x32_bf16 v[148:151], v[212:215], v[124:127], v[148:151]
    v_mfma_f32_16x16x32_bf16 v[144:147], v[208:211], v[104:107], v[144:147]
    ds_read_b128 v[208:211], v245 offset:7168
    v_mfma_f32_16x16x32_bf16 v[144:147], v[212:215], v[108:111], v[144:147]
    ds_read_b128 v[212:215], v244 offset:8192
    s_waitcnt lgkmcnt(3)
    v_mfma_f32_16x16x32_bf16 v[156:159], v[216:219], v[96:99], 0
    v_mfma_f32_16x16x32_bf16 v[156:159], v[200:203], v[100:103], v[156:159]
    v_mfma_f32_16x16x32_bf16 v[160:163], v[216:219], v[112:115], 0
    v_mfma_f32_16x16x32_bf16 v[160:163], v[200:203], v[116:119], v[160:163]
    v_mfma_f32_16x16x32_bf16 v[164:167], v[216:219], v[128:131], 0
    ds_read_b128 v[216:219], v245 offset:9216
    v_mfma_f32_16x16x32_bf16 v[164:167], v[200:203], v[132:135], v[164:167]
    ds_read_b128 v[200:203], v244 offset:10240
    s_waitcnt lgkmcnt(3)
    v_mfma_f32_16x16x32_bf16 v[164:167], v[204:207], v[136:139], v[164:167]
    v_mfma_f32_16x16x32_bf16 v[164:167], v[208:211], v[140:143], v[164:167]
    v_mfma_f32_16x16x32_bf16 v[160:163], v[204:207], v[120:123], v[160:163]
    v_mfma_f32_16x16x32_bf16 v[160:163], v[208:211], v[124:127], v[160:163]
    v_mfma_f32_16x16x32_bf16 v[156:159], v[204:207], v[104:107], v[156:159]
    ds_read_b128 v[204:207], v245 offset:11264
    v_mfma_f32_16x16x32_bf16 v[156:159], v[208:211], v[108:111], v[156:159]
    ds_read_b128 v[208:211], v244 offset:12288
    s_waitcnt lgkmcnt(3)
    s_setprio 0
    v_max_f32 v232, v144, v145
    v_max3_f32 v232, v146, v147, v232
    v_max_f32 v233, v148, v149
    v_max3_f32 v233, v150, v151, v233
    v_max_f32 v234, v152, v153
    v_max3_f32 v234, v154, v155, v234
    v_max3_f32 v232, v156, v157, v232
    v_max3_f32 v232, v158, v159, v232
    v_max3_f32 v233, v160, v161, v233
    v_max3_f32 v233, v162, v163, v233
    v_max3_f32 v234, v164, v165, v234
    v_max3_f32 v234, v166, v167, v234
    v_mov_b32 v235, v234
    v_permlane32_swap_b32 v232, v233
    s_nop 0
    v_permlane32_swap_b32 v234, v235
    v_max_f32 v232, v232, v233
    v_max_f32 v234, v234, v235
    v_mov_b32 v233, v232
    v_mov_b32 v235, v234
    s_nop 0
    v_permlane16_swap_b32 v232, v233
    v_permlane16_swap_b32 v234, v235
    v_max_f32 v232, v232, v233
    v_max_f32 v234, v234, v235
    v_sub_f32 v220, 0, v232
    v_sub_f32 v224, 0, v232
    v_sub_f32 v228, 0, v234
    s_nop 0
    v_permlane32_swap_b32 v220, v224
    v_mov_b32 v229, v228
    v_mov_b32 v230, v228
    v_mov_b32 v231, v228
    v_mov_b32 v225, v224
    v_mov_b32 v226, v224
    v_mov_b32 v227, v224
    v_mov_b32 v221, v220
    v_mov_b32 v222, v220
    v_mov_b32 v223, v220
    v_mov_b32 v232, 0
    v_mov_b32 v233, 0
    v_mov_b32 v234, 0
    v_mov_b32 v235, 0
    v_mov_b32 v236, 0
    v_mov_b32 v237, 0
    v_mov_b32 v238, 0
    v_mov_b32 v239, 0
    v_add_f32 v144, v220, v144
    v_exp_f32 v144, v144
    v_add_f32 v145, v220, v145
    v_exp_f32 v145, v145
    v_add_f32 v146, v220, v146
    v_cvt_pk_bf16_f32 v176, v144, v145
    v_exp_f32 v146, v146
    v_add_f32 v147, v220, v147
    v_exp_f32 v147, v147
    v_add_f32 v148, v224, v148
    v_cvt_pk_bf16_f32 v177, v146, v147
    v_exp_f32 v148, v148
    v_add_f32 v149, v224, v149
    v_exp_f32 v149, v149
    v_add_f32 v150, v224, v150
    v_cvt_pk_bf16_f32 v180, v148, v149
    v_exp_f32 v150, v150
    v_add_f32 v151, v224, v151
    v_exp_f32 v151, v151
    v_add_f32 v152, v228, v152
    v_cvt_pk_bf16_f32 v181, v150, v151
    v_exp_f32 v152, v152
    v_add_f32 v153, v228, v153
    v_exp_f32 v153, v153
    v_add_f32 v154, v228, v154
    v_cvt_pk_bf16_f32 v192, v152, v153
    v_exp_f32 v154, v154
    v_add_f32 v155, v228, v155
    v_exp_f32 v155, v155
    v_add_f32 v156, v220, v156
    v_cvt_pk_bf16_f32 v193, v154, v155
    s_setprio 3
    v_mfma_f32_16x16x32_bf16 v[168:171], v[212:215], v[96:99], v[220:223]
    v_exp_f32 v156, v156
    v_mfma_f32_16x16x32_bf16 v[168:171], v[216:219], v[100:103], v[168:171]
    v_add_f32 v157, v220, v157
    v_add_f32 v158, v220, v158
    v_mfma_f32_16x16x32_bf16 v[172:175], v[212:215], v[112:115], v[224:227]
    v_exp_f32 v157, v157
    v_mfma_f32_16x16x32_bf16 v[172:175], v[216:219], v[116:119], v[172:175]
    v_exp_f32 v158, v158
    v_mfma_f32_16x16x32_bf16 v[144:147], v[212:215], v[128:131], v[228:231]
    ds_read_b128 v[212:215], v245 offset:13312
    v_cvt_pk_bf16_f32 v178, v156, v157
    v_mfma_f32_16x16x32_bf16 v[144:147], v[216:219], v[132:135], v[144:147]
    ds_read_b128 v[216:219], v244 offset:14336
    s_waitcnt lgkmcnt(3)
    v_mfma_f32_16x16x32_bf16 v[144:147], v[200:203], v[136:139], v[144:147]
    v_add_f32 v159, v220, v159
    v_add_f32 v160, v224, v160
    v_mfma_f32_16x16x32_bf16 v[144:147], v[204:207], v[140:143], v[144:147]
    v_exp_f32 v159, v159
    v_mfma_f32_16x16x32_bf16 v[172:175], v[200:203], v[120:123], v[172:175]
    v_exp_f32 v160, v160
    v_mfma_f32_16x16x32_bf16 v[172:175], v[204:207], v[124:127], v[172:175]
    v_cvt_pk_bf16_f32 v179, v158, v159
    v_add_f32 v161, v224, v161
    v_mfma_f32_16x16x32_bf16 v[168:171], v[200:203], v[104:107], v[168:171]
    ds_read_b128 v[200:203], v245 offset:15360
    v_add_f32 v162, v224, v162
    v_mfma_f32_16x16x32_bf16 v[168:171], v[204:207], v[108:111], v[168:171]
    ds_read_b128 v[204:207], v248 offset:0
    s_waitcnt lgkmcnt(3)
    v_mfma_f32_16x16x32_bf16 v[148:151], v[208:211], v[96:99], v[220:223]
    v_exp_f32 v161, v161
    v_mfma_f32_16x16x32_bf16 v[148:151], v[212:215], v[100:103], v[148:151]
    v_exp_f32 v162, v162
    v_mfma_f32_16x16x32_bf16 v[152:155], v[208:211], v[112:115], v[224:227]
    v_cvt_pk_bf16_f32 v182, v160, v161
    v_add_f32 v163, v224, v163
    v_mfma_f32_16x16x32_bf16 v[152:155], v[212:215], v[116:119], v[152:155]
    v_exp_f32 v163, v163
    v_mfma_f32_16x16x32_bf16 v[156:159], v[208:211], v[128:131], v[228:231]
    ds_read_b128 v[208:211], v248 offset:1024
    v_cvt_pk_bf16_f32 v183, v162, v163
    v_mfma_f32_16x16x32_bf16 v[156:159], v[212:215], v[132:135], v[156:159]
    ds_read_b128 v[212:215], v248 offset:2048
    s_waitcnt lgkmcnt(3)
    v_mfma_f32_16x16x32_bf16 v[156:159], v[216:219], v[136:139], v[156:159]
    v_add_f32 v164, v228, v164
    v_add_f32 v165, v228, v165
    v_mfma_f32_16x16x32_bf16 v[156:159], v[200:203], v[140:143], v[156:159]
    v_exp_f32 v164, v164
    v_mfma_f32_16x16x32_bf16 v[152:155], v[216:219], v[120:123], v[152:155]
    v_exp_f32 v165, v165
    v_mfma_f32_16x16x32_bf16 v[152:155], v[200:203], v[124:127], v[152:155]
    v_cvt_pk_bf16_f32 v194, v164, v165
    v_add_f32 v166, v228, v166
    v_mfma_f32_16x16x32_bf16 v[148:151], v[216:219], v[104:107], v[148:151]
    ds_read_b128 v[216:219], v248 offset:3072
    v_add_f32 v167, v228, v167
    v_mfma_f32_16x16x32_bf16 v[148:151], v[200:203], v[108:111], v[148:151]
    ds_read_b128 v[200:203], v248 offset:4096
    s_waitcnt lgkmcnt(3)
    s_setprio 1
    v_exp_f32 v166, v166
    v_exp_f32 v167, v167
    s_nop 0
    v_cvt_pk_bf16_f32 v195, v166, v167
    v_smfmac_f32_16x16x64_bf16 v[232:235], v[240:243], v[176:183], v252
    v_mfma_f32_16x16x32_bf16 v[0:3], v[176:179], v[204:207], 0
    v_exp_f32 v144, v144
    v_mfma_f32_16x16x32_bf16 v[32:35], v[180:183], v[204:207], 0
    v_exp_f32 v145, v145
    v_mfma_f32_16x16x32_bf16 v[64:67], v[192:195], v[204:207], 0
    ds_read_b128 v[204:207], v248 offset:5120
    v_cvt_pk_bf16_f32 v196, v144, v145
    v_mfma_f32_16x16x32_bf16 v[4:7], v[176:179], v[208:211], 0
    v_exp_f32 v146, v146
    v_mfma_f32_16x16x32_bf16 v[36:39], v[180:183], v[208:211], 0
    v_exp_f32 v147, v147
    v_mfma_f32_16x16x32_bf16 v[68:71], v[192:195], v[208:211], 0
    ds_read_b128 v[208:211], v248 offset:6144
    s_waitcnt lgkmcnt(3)
    v_mfma_f32_16x16x32_bf16 v[8:11], v[176:179], v[212:215], 0
    v_exp_f32 v172, v172
    v_mfma_f32_16x16x32_bf16 v[40:43], v[180:183], v[212:215], 0
    v_exp_f32 v173, v173
    v_mfma_f32_16x16x32_bf16 v[72:75], v[192:195], v[212:215], 0
    ds_read_b128 v[212:215], v248 offset:7168
    v_cvt_pk_bf16_f32 v197, v146, v147
    v_mfma_f32_16x16x32_bf16 v[12:15], v[176:179], v[216:219], 0
    v_exp_f32 v174, v174
    v_mfma_f32_16x16x32_bf16 v[44:47], v[180:183], v[216:219], 0
    v_exp_f32 v175, v175
    v_mfma_f32_16x16x32_bf16 v[76:79], v[192:195], v[216:219], 0
    ds_read_b128 v[216:219], v244 offset:16384
    s_waitcnt lgkmcnt(3)
    v_mfma_f32_16x16x32_bf16 v[16:19], v[176:179], v[200:203], 0
    v_cvt_pk_bf16_f32 v188, v172, v173
    v_cvt_pk_bf16_f32 v189, v174, v175
    v_mfma_f32_16x16x32_bf16 v[48:51], v[180:183], v[200:203], 0
    v_exp_f32 v168, v168
    v_mfma_f32_16x16x32_bf16 v[80:83], v[192:195], v[200:203], 0
    ds_read_b128 v[200:203], v245 offset:17408
    v_mfma_f32_16x16x32_bf16 v[20:23], v[176:179], v[204:207], 0
    v_exp_f32 v169, v169
    v_mfma_f32_16x16x32_bf16 v[52:55], v[180:183], v[204:207], 0
    v_exp_f32 v170, v170
    v_mfma_f32_16x16x32_bf16 v[84:87], v[192:195], v[204:207], 0
    ds_read_b128 v[204:207], v244 offset:18432
    s_waitcnt lgkmcnt(3)
    v_mfma_f32_16x16x32_bf16 v[24:27], v[176:179], v[208:211], 0
    v_exp_f32 v171, v171
    v_mfma_f32_16x16x32_bf16 v[56:59], v[180:183], v[208:211], 0
    v_cvt_pk_bf16_f32 v184, v168, v169
    v_cvt_pk_bf16_f32 v185, v170, v171
    v_mfma_f32_16x16x32_bf16 v[88:91], v[192:195], v[208:211], 0
    ds_read_b128 v[208:211], v245 offset:19456
    v_mfma_f32_16x16x32_bf16 v[28:31], v[176:179], v[212:215], 0
    v_exp_f32 v156, v156
    v_mfma_f32_16x16x32_bf16 v[60:63], v[180:183], v[212:215], 0
    v_exp_f32 v157, v157
    v_mfma_f32_16x16x32_bf16 v[92:95], v[192:195], v[212:215], 0
    ds_read_b128 v[212:215], v244 offset:20480
    s_waitcnt lgkmcnt(3)
    v_mfma_f32_16x16x32_bf16 v[160:163], v[216:219], v[96:99], v[220:223]
    v_exp_f32 v158, v158
    v_mfma_f32_16x16x32_bf16 v[160:163], v[200:203], v[100:103], v[160:163]
    v_exp_f32 v159, v159
    v_mfma_f32_16x16x32_bf16 v[164:167], v[216:219], v[112:115], v[224:227]
    v_cvt_pk_bf16_f32 v198, v156, v157
    v_cvt_pk_bf16_f32 v199, v158, v159
    v_mfma_f32_16x16x32_bf16 v[164:167], v[200:203], v[116:119], v[164:167]
    v_exp_f32 v152, v152
    v_mfma_f32_16x16x32_bf16 v[144:147], v[216:219], v[128:131], v[228:231]
    ds_read_b128 v[216:219], v245 offset:21504
    v_mfma_f32_16x16x32_bf16 v[144:147], v[200:203], v[132:135], v[144:147]
    ds_read_b128 v[200:203], v244 offset:22528
    s_waitcnt lgkmcnt(3)
    v_mfma_f32_16x16x32_bf16 v[144:147], v[204:207], v[136:139], v[144:147]
    v_exp_f32 v153, v153
    v_mfma_f32_16x16x32_bf16 v[144:147], v[208:211], v[140:143], v[144:147]
    v_exp_f32 v154, v154
    v_mfma_f32_16x16x32_bf16 v[164:167], v[204:207], v[120:123], v[164:167]
    v_exp_f32 v155, v155
    v_mfma_f32_16x16x32_bf16 v[164:167], v[208:211], v[124:127], v[164:167]
    v_cvt_pk_bf16_f32 v190, v152, v153
    v_cvt_pk_bf16_f32 v191, v154, v155
    v_mfma_f32_16x16x32_bf16 v[160:163], v[204:207], v[104:107], v[160:163]
    ds_read_b128 v[204:207], v245 offset:23552
    v_mfma_f32_16x16x32_bf16 v[160:163], v[208:211], v[108:111], v[160:163]
    ds_read_b128 v[208:211], v248 offset:8192
    s_waitcnt lgkmcnt(3)
    v_mfma_f32_16x16x32_bf16 v[172:175], v[212:215], v[96:99], v[220:223]
    v_exp_f32 v148, v148
    v_mfma_f32_16x16x32_bf16 v[172:175], v[216:219], v[100:103], v[172:175]
    v_exp_f32 v149, v149
    v_mfma_f32_16x16x32_bf16 v[168:171], v[212:215], v[112:115], v[224:227]
    v_exp_f32 v150, v150
    v_mfma_f32_16x16x32_bf16 v[168:171], v[216:219], v[116:119], v[168:171]
    v_exp_f32 v151, v151
    v_mfma_f32_16x16x32_bf16 v[156:159], v[212:215], v[128:131], v[228:231]
    ds_read_b128 v[212:215], v248 offset:9216
    v_cvt_pk_bf16_f32 v186, v148, v149
    v_mfma_f32_16x16x32_bf16 v[156:159], v[216:219], v[132:135], v[156:159]
    ds_read_b128 v[216:219], v248 offset:10240
    s_waitcnt lgkmcnt(3)
    v_mfma_f32_16x16x32_bf16 v[156:159], v[200:203], v[136:139], v[156:159]
    v_exp_f32 v144, v144
    v_mfma_f32_16x16x32_bf16 v[156:159], v[204:207], v[140:143], v[156:159]
    v_exp_f32 v145, v145
    v_mfma_f32_16x16x32_bf16 v[168:171], v[200:203], v[120:123], v[168:171]
    v_exp_f32 v146, v146
    v_mfma_f32_16x16x32_bf16 v[168:171], v[204:207], v[124:127], v[168:171]
    v_exp_f32 v147, v147
    v_mfma_f32_16x16x32_bf16 v[172:175], v[200:203], v[104:107], v[172:175]
    ds_read_b128 v[200:203], v248 offset:11264
    v_cvt_pk_bf16_f32 v187, v150, v151
    v_mfma_f32_16x16x32_bf16 v[172:175], v[204:207], v[108:111], v[172:175]
    ds_read_b128 v[204:207], v248 offset:12288
    s_waitcnt lgkmcnt(3)
    v_smfmac_f32_16x16x64_bf16 v[232:235], v[240:243], v[184:191], v252
    v_smfmac_f32_16x16x64_bf16 v[236:239], v[240:243], v[192:199], v252
    v_cvt_pk_bf16_f32 v192, v144, v145
    v_mfma_f32_16x16x32_bf16 v[0:3], v[184:187], v[208:211], v[0:3]
    v_exp_f32 v164, v164
    v_mfma_f32_16x16x32_bf16 v[32:35], v[188:191], v[208:211], v[32:35]
    v_exp_f32 v165, v165
    v_mfma_f32_16x16x32_bf16 v[64:67], v[196:199], v[208:211], v[64:67]
    ds_read_b128 v[208:211], v248 offset:13312
    v_cvt_pk_bf16_f32 v193, v146, v147
    v_mfma_f32_16x16x32_bf16 v[4:7], v[184:187], v[212:215], v[4:7]
    v_exp_f32 v166, v166
    v_mfma_f32_16x16x32_bf16 v[36:39], v[188:191], v[212:215], v[36:39]
    v_exp_f32 v167, v167
    v_mfma_f32_16x16x32_bf16 v[68:71], v[196:199], v[212:215], v[68:71]
    ds_read_b128 v[212:215], v248 offset:14336
    s_waitcnt lgkmcnt(3)
    v_mfma_f32_16x16x32_bf16 v[8:11], v[184:187], v[216:219], v[8:11]
    v_cvt_pk_bf16_f32 v180, v164, v165
    v_cvt_pk_bf16_f32 v181, v166, v167
    v_mfma_f32_16x16x32_bf16 v[40:43], v[188:191], v[216:219], v[40:43]
    v_exp_f32 v160, v160
    v_mfma_f32_16x16x32_bf16 v[72:75], v[196:199], v[216:219], v[72:75]
    ds_read_b128 v[216:219], v248 offset:15360
    v_mfma_f32_16x16x32_bf16 v[12:15], v[184:187], v[200:203], v[12:15]
    v_exp_f32 v161, v161
    v_mfma_f32_16x16x32_bf16 v[44:47], v[188:191], v[200:203], v[44:47]
    v_exp_f32 v162, v162
    v_mfma_f32_16x16x32_bf16 v[76:79], v[196:199], v[200:203], v[76:79]
    ds_read_b128 v[200:203], v244 offset:24576
    s_waitcnt lgkmcnt(3)
    v_mfma_f32_16x16x32_bf16 v[16:19], v[184:187], v[204:207], v[16:19]
    v_exp_f32 v163, v163
    v_mfma_f32_16x16x32_bf16 v[48:51], v[188:191], v[204:207], v[48:51]
    v_cvt_pk_bf16_f32 v176, v160, v161
    v_cvt_pk_bf16_f32 v177, v162, v163
    v_mfma_f32_16x16x32_bf16 v[80:83], v[196:199], v[204:207], v[80:83]
    ds_read_b128 v[204:207], v245 offset:25600
    v_mfma_f32_16x16x32_bf16 v[20:23], v[184:187], v[208:211], v[20:23]
    v_exp_f32 v156, v156
    v_mfma_f32_16x16x32_bf16 v[52:55], v[188:191], v[208:211], v[52:55]
    v_exp_f32 v157, v157
    v_mfma_f32_16x16x32_bf16 v[84:87], v[196:199], v[208:211], v[84:87]
    ds_read_b128 v[208:211], v244 offset:26624
    s_waitcnt lgkmcnt(3)
    v_mfma_f32_16x16x32_bf16 v[24:27], v[184:187], v[212:215], v[24:27]
    v_exp_f32 v158, v158
    v_mfma_f32_16x16x32_bf16 v[56:59], v[188:191], v[212:215], v[56:59]
    v_exp_f32 v159, v159
    v_mfma_f32_16x16x32_bf16 v[88:91], v[196:199], v[212:215], v[88:91]
    ds_read_b128 v[212:215], v245 offset:27648
    v_cvt_pk_bf16_f32 v194, v156, v157
    v_mfma_f32_16x16x32_bf16 v[28:31], v[184:187], v[216:219], v[28:31]
    v_exp_f32 v168, v168
    v_mfma_f32_16x16x32_bf16 v[60:63], v[188:191], v[216:219], v[60:63]
    v_exp_f32 v169, v169
    v_mfma_f32_16x16x32_bf16 v[92:95], v[196:199], v[216:219], v[92:95]
    ds_read_b128 v[216:219], v244 offset:28672
    s_waitcnt lgkmcnt(3)
    s_setprio 2
    v_mfma_f32_16x16x32_bf16 v[152:155], v[200:203], v[96:99], v[220:223]
    v_cvt_pk_bf16_f32 v195, v158, v159
    v_cvt_pk_bf16_f32 v182, v168, v169
    v_mfma_f32_16x16x32_bf16 v[152:155], v[204:207], v[100:103], v[152:155]
    v_exp_f32 v170, v170
    v_mfma_f32_16x16x32_bf16 v[148:151], v[200:203], v[112:115], v[224:227]
    v_exp_f32 v171, v171
    v_mfma_f32_16x16x32_bf16 v[148:151], v[204:207], v[116:119], v[148:151]
    v_exp_f32 v172, v172
    v_mfma_f32_16x16x32_bf16 v[144:147], v[200:203], v[128:131], v[228:231]
    ds_read_b128 v[200:203], v245 offset:29696
    v_cvt_pk_bf16_f32 v183, v170, v171
    v_mfma_f32_16x16x32_bf16 v[144:147], v[204:207], v[132:135], v[144:147]
    ds_read_b128 v[204:207], v244 offset:30720
    s_waitcnt lgkmcnt(3)
    v_mfma_f32_16x16x32_bf16 v[144:147], v[208:211], v[136:139], v[144:147]
    v_exp_f32 v173, v173
    v_mfma_f32_16x16x32_bf16 v[144:147], v[212:215], v[140:143], v[144:147]
    v_exp_f32 v174, v174
    v_mfma_f32_16x16x32_bf16 v[148:151], v[208:211], v[120:123], v[148:151]
    v_exp_f32 v175, v175
    v_mfma_f32_16x16x32_bf16 v[148:151], v[212:215], v[124:127], v[148:151]
    v_cvt_pk_bf16_f32 v178, v172, v173
    v_cvt_pk_bf16_f32 v179, v174, v175
    v_mfma_f32_16x16x32_bf16 v[152:155], v[208:211], v[104:107], v[152:155]
    ds_read_b128 v[208:211], v245 offset:31744
    v_mfma_f32_16x16x32_bf16 v[152:155], v[212:215], v[108:111], v[152:155]
    ds_read_b128 v[212:215], v248 offset:16384
    s_waitcnt lgkmcnt(3)
    v_mfma_f32_16x16x32_bf16 v[164:167], v[216:219], v[96:99], v[220:223]
    v_exp_f32 v144, v144
    v_mfma_f32_16x16x32_bf16 v[164:167], v[200:203], v[100:103], v[164:167]
    v_exp_f32 v145, v145
    v_mfma_f32_16x16x32_bf16 v[160:163], v[216:219], v[112:115], v[224:227]
    v_exp_f32 v146, v146
    v_mfma_f32_16x16x32_bf16 v[160:163], v[200:203], v[116:119], v[160:163]
    v_exp_f32 v147, v147
    v_mfma_f32_16x16x32_bf16 v[156:159], v[216:219], v[128:131], v[228:231]
    ds_read_b128 v[216:219], v248 offset:17408
    v_cvt_pk_bf16_f32 v196, v144, v145
    v_mfma_f32_16x16x32_bf16 v[156:159], v[200:203], v[132:135], v[156:159]
    ds_read_b128 v[200:203], v248 offset:18432
    s_waitcnt lgkmcnt(3)
    v_mfma_f32_16x16x32_bf16 v[156:159], v[204:207], v[136:139], v[156:159]
    v_exp_f32 v148, v148
    v_mfma_f32_16x16x32_bf16 v[156:159], v[208:211], v[140:143], v[156:159]
    v_exp_f32 v149, v149
    v_mfma_f32_16x16x32_bf16 v[160:163], v[204:207], v[120:123], v[160:163]
    v_cvt_pk_bf16_f32 v197, v146, v147
    v_cvt_pk_bf16_f32 v188, v148, v149
    v_mfma_f32_16x16x32_bf16 v[160:163], v[208:211], v[124:127], v[160:163]
    v_exp_f32 v150, v150
    v_mfma_f32_16x16x32_bf16 v[164:167], v[204:207], v[104:107], v[164:167]
    ds_read_b128 v[204:207], v248 offset:19456
    v_mfma_f32_16x16x32_bf16 v[164:167], v[208:211], v[108:111], v[164:167]
    ds_read_b128 v[208:211], v248 offset:20480
    s_waitcnt lgkmcnt(3)
    v_smfmac_f32_16x16x64_bf16 v[232:235], v[240:243], v[176:183], v252
    v_mfma_f32_16x16x32_bf16 v[0:3], v[176:179], v[212:215], v[0:3]
    v_exp_f32 v151, v151
    v_mfma_f32_16x16x32_bf16 v[32:35], v[180:183], v[212:215], v[32:35]
    v_exp_f32 v152, v152
    v_mfma_f32_16x16x32_bf16 v[64:67], v[192:195], v[212:215], v[64:67]
    ds_read_b128 v[212:215], v248 offset:21504
    v_cvt_pk_bf16_f32 v189, v150, v151
    v_mfma_f32_16x16x32_bf16 v[4:7], v[176:179], v[216:219], v[4:7]
    v_exp_f32 v153, v153
    v_mfma_f32_16x16x32_bf16 v[36:39], v[180:183], v[216:219], v[36:39]
    v_exp_f32 v154, v154
    v_mfma_f32_16x16x32_bf16 v[68:71], v[192:195], v[216:219], v[68:71]
    ds_read_b128 v[216:219], v248 offset:22528
    s_waitcnt lgkmcnt(3)
    v_mfma_f32_16x16x32_bf16 v[8:11], v[176:179], v[200:203], v[8:11]
    v_exp_f32 v155, v155
    v_mfma_f32_16x16x32_bf16 v[40:43], v[180:183], v[200:203], v[40:43]
    v_cvt_pk_bf16_f32 v184, v152, v153
    v_cvt_pk_bf16_f32 v185, v154, v155
    v_mfma_f32_16x16x32_bf16 v[72:75], v[192:195], v[200:203], v[72:75]
    ds_read_b128 v[200:203], v248 offset:23552
    v_mfma_f32_16x16x32_bf16 v[12:15], v[176:179], v[204:207], v[12:15]
    v_exp_f32 v156, v156
    v_mfma_f32_16x16x32_bf16 v[44:47], v[180:183], v[204:207], v[44:47]
    v_exp_f32 v157, v157
    v_mfma_f32_16x16x32_bf16 v[76:79], v[192:195], v[204:207], v[76:79]
    ds_read_b128 v[204:207], v244 offset:32768
    s_waitcnt lgkmcnt(3)
    v_mfma_f32_16x16x32_bf16 v[16:19], v[176:179], v[208:211], v[16:19]
    v_exp_f32 v158, v158
    v_mfma_f32_16x16x32_bf16 v[48:51], v[180:183], v[208:211], v[48:51]
    v_exp_f32 v159, v159
    v_mfma_f32_16x16x32_bf16 v[80:83], v[192:195], v[208:211], v[80:83]
    ds_read_b128 v[208:211], v245 offset:33792
    v_cvt_pk_bf16_f32 v198, v156, v157
    v_mfma_f32_16x16x32_bf16 v[20:23], v[176:179], v[212:215], v[20:23]
    v_exp_f32 v160, v160
    v_mfma_f32_16x16x32_bf16 v[52:55], v[180:183], v[212:215], v[52:55]
    v_exp_f32 v161, v161
    v_mfma_f32_16x16x32_bf16 v[84:87], v[192:195], v[212:215], v[84:87]
    ds_read_b128 v[212:215], v244 offset:34816
    s_waitcnt lgkmcnt(3)
    v_mfma_f32_16x16x32_bf16 v[24:27], v[176:179], v[216:219], v[24:27]
    v_cvt_pk_bf16_f32 v199, v158, v159
    v_cvt_pk_bf16_f32 v190, v160, v161
    v_mfma_f32_16x16x32_bf16 v[56:59], v[180:183], v[216:219], v[56:59]
    v_exp_f32 v162, v162
    v_mfma_f32_16x16x32_bf16 v[88:91], v[192:195], v[216:219], v[88:91]
    ds_read_b128 v[216:219], v245 offset:35840
    v_mfma_f32_16x16x32_bf16 v[28:31], v[176:179], v[200:203], v[28:31]
    v_exp_f32 v163, v163
    v_mfma_f32_16x16x32_bf16 v[60:63], v[180:183], v[200:203], v[60:63]
    v_exp_f32 v164, v164
    v_mfma_f32_16x16x32_bf16 v[92:95], v[192:195], v[200:203], v[92:95]
    ds_read_b128 v[200:203], v244 offset:36864
    s_waitcnt lgkmcnt(3)
    v_mfma_f32_16x16x32_bf16 v[168:171], v[204:207], v[96:99], v[220:223]
    v_exp_f32 v165, v165
    v_mfma_f32_16x16x32_bf16 v[168:171], v[208:211], v[100:103], v[168:171]
    v_cvt_pk_bf16_f32 v191, v162, v163
    v_cvt_pk_bf16_f32 v186, v164, v165
    v_mfma_f32_16x16x32_bf16 v[172:175], v[204:207], v[112:115], v[224:227]
    v_exp_f32 v166, v166
    v_mfma_f32_16x16x32_bf16 v[172:175], v[208:211], v[116:119], v[172:175]
    v_exp_f32 v167, v167
    v_mfma_f32_16x16x32_bf16 v[144:147], v[204:207], v[128:131], v[228:231]
    ds_read_b128 v[204:207], v245 offset:37888
    v_cvt_pk_bf16_f32 v187, v166, v167
    v_mfma_f32_16x16x32_bf16 v[144:147], v[208:211], v[132:135], v[144:147]
    ds_read_b128 v[208:211], v244 offset:38912
    s_waitcnt lgkmcnt(3)
    v_mfma_f32_16x16x32_bf16 v[144:147], v[212:215], v[136:139], v[144:147]
    v_mfma_f32_16x16x32_bf16 v[144:147], v[216:219], v[140:143], v[144:147]
    v_mfma_f32_16x16x32_bf16 v[172:175], v[212:215], v[120:123], v[172:175]
    v_mfma_f32_16x16x32_bf16 v[172:175], v[216:219], v[124:127], v[172:175]
    v_mfma_f32_16x16x32_bf16 v[168:171], v[212:215], v[104:107], v[168:171]
    ds_read_b128 v[212:215], v245 offset:39936
    v_mfma_f32_16x16x32_bf16 v[168:171], v[216:219], v[108:111], v[168:171]
    ds_read_b128 v[216:219], v248 offset:24576
    s_waitcnt lgkmcnt(3)
    v_mfma_f32_16x16x32_bf16 v[148:151], v[200:203], v[96:99], v[220:223]
    v_exp_f32 v144, v144
    v_mfma_f32_16x16x32_bf16 v[148:151], v[204:207], v[100:103], v[148:151]
    v_exp_f32 v145, v145
    v_mfma_f32_16x16x32_bf16 v[152:155], v[200:203], v[112:115], v[224:227]
    v_exp_f32 v146, v146
    v_mfma_f32_16x16x32_bf16 v[152:155], v[204:207], v[116:119], v[152:155]
    v_exp_f32 v147, v147
    v_mfma_f32_16x16x32_bf16 v[156:159], v[200:203], v[128:131], v[228:231]
    ds_read_b128 v[200:203], v248 offset:25600
    v_mfma_f32_16x16x32_bf16 v[156:159], v[204:207], v[132:135], v[156:159]
    ds_read_b128 v[204:207], v248 offset:26624
    s_waitcnt lgkmcnt(3)
    v_mfma_f32_16x16x32_bf16 v[156:159], v[208:211], v[136:139], v[156:159]
    v_exp_f32 v172, v172
    v_mfma_f32_16x16x32_bf16 v[156:159], v[212:215], v[140:143], v[156:159]
    v_exp_f32 v173, v173
    v_mfma_f32_16x16x32_bf16 v[152:155], v[208:211], v[120:123], v[152:155]
    v_exp_f32 v174, v174
    v_mfma_f32_16x16x32_bf16 v[152:155], v[212:215], v[124:127], v[152:155]
    v_exp_f32 v175, v175
    v_mfma_f32_16x16x32_bf16 v[148:151], v[208:211], v[104:107], v[148:151]
    ds_read_b128 v[208:211], v248 offset:27648
    v_cvt_pk_bf16_f32 v180, v172, v173
    v_mfma_f32_16x16x32_bf16 v[148:151], v[212:215], v[108:111], v[148:151]
    ds_read_b128 v[212:215], v248 offset:28672
    s_waitcnt lgkmcnt(3)
    v_smfmac_f32_16x16x64_bf16 v[232:235], v[240:243], v[184:191], v252
    v_cvt_pk_bf16_f32 v181, v174, v175
    v_smfmac_f32_16x16x64_bf16 v[236:239], v[240:243], v[192:199], v252
    v_cvt_pk_bf16_f32 v192, v144, v145
    v_mfma_f32_16x16x32_bf16 v[0:3], v[184:187], v[216:219], v[0:3]
    v_exp_f32 v168, v168
    v_mfma_f32_16x16x32_bf16 v[32:35], v[188:191], v[216:219], v[32:35]
    v_exp_f32 v169, v169
    v_mfma_f32_16x16x32_bf16 v[64:67], v[196:199], v[216:219], v[64:67]
    ds_read_b128 v[216:219], v248 offset:29696
    v_cvt_pk_bf16_f32 v193, v146, v147
    v_mfma_f32_16x16x32_bf16 v[4:7], v[184:187], v[200:203], v[4:7]
    v_exp_f32 v170, v170
    v_mfma_f32_16x16x32_bf16 v[36:39], v[188:191], v[200:203], v[36:39]
    v_exp_f32 v171, v171
    v_mfma_f32_16x16x32_bf16 v[68:71], v[196:199], v[200:203], v[68:71]
    ds_read_b128 v[200:203], v248 offset:30720
    s_waitcnt lgkmcnt(3)
    v_mfma_f32_16x16x32_bf16 v[8:11], v[184:187], v[204:207], v[8:11]
    v_cvt_pk_bf16_f32 v176, v168, v169
    v_cvt_pk_bf16_f32 v177, v170, v171
    v_mfma_f32_16x16x32_bf16 v[40:43], v[188:191], v[204:207], v[40:43]
    v_exp_f32 v156, v156
    v_mfma_f32_16x16x32_bf16 v[72:75], v[196:199], v[204:207], v[72:75]
    ds_read_b128 v[204:207], v248 offset:31744
    v_mfma_f32_16x16x32_bf16 v[12:15], v[184:187], v[208:211], v[12:15]
    v_exp_f32 v157, v157
    v_mfma_f32_16x16x32_bf16 v[44:47], v[188:191], v[208:211], v[44:47]
    v_exp_f32 v158, v158
    v_mfma_f32_16x16x32_bf16 v[76:79], v[196:199], v[208:211], v[76:79]
    ds_read_b128 v[208:211], v244 offset:40960
    s_waitcnt lgkmcnt(3)
    v_mfma_f32_16x16x32_bf16 v[16:19], v[184:187], v[212:215], v[16:19]
    v_exp_f32 v159, v159
    v_mfma_f32_16x16x32_bf16 v[48:51], v[188:191], v[212:215], v[48:51]
    v_cvt_pk_bf16_f32 v194, v156, v157
    v_cvt_pk_bf16_f32 v195, v158, v159
    v_mfma_f32_16x16x32_bf16 v[80:83], v[196:199], v[212:215], v[80:83]
    ds_read_b128 v[212:215], v245 offset:41984
    v_mfma_f32_16x16x32_bf16 v[20:23], v[184:187], v[216:219], v[20:23]
    v_exp_f32 v152, v152
    v_mfma_f32_16x16x32_bf16 v[52:55], v[188:191], v[216:219], v[52:55]
    v_exp_f32 v153, v153
    v_mfma_f32_16x16x32_bf16 v[84:87], v[196:199], v[216:219], v[84:87]
    ds_read_b128 v[216:219], v244 offset:43008
    s_waitcnt lgkmcnt(3)
    v_mfma_f32_16x16x32_bf16 v[24:27], v[184:187], v[200:203], v[24:27]
    v_exp_f32 v154, v154
    v_mfma_f32_16x16x32_bf16 v[56:59], v[188:191], v[200:203], v[56:59]
    v_exp_f32 v155, v155
    v_mfma_f32_16x16x32_bf16 v[88:91], v[196:199], v[200:203], v[88:91]
    ds_read_b128 v[200:203], v245 offset:44032
    v_cvt_pk_bf16_f32 v182, v152, v153
    v_mfma_f32_16x16x32_bf16 v[28:31], v[184:187], v[204:207], v[28:31]
    v_exp_f32 v148, v148
    v_mfma_f32_16x16x32_bf16 v[60:63], v[188:191], v[204:207], v[60:63]
    v_exp_f32 v149, v149
    v_mfma_f32_16x16x32_bf16 v[92:95], v[196:199], v[204:207], v[92:95]
    ds_read_b128 v[204:207], v244 offset:45056
    s_waitcnt lgkmcnt(3)
    v_mfma_f32_16x16x32_bf16 v[160:163], v[208:211], v[96:99], v[220:223]
    v_cvt_pk_bf16_f32 v183, v154, v155
    v_cvt_pk_bf16_f32 v178, v148, v149
    v_mfma_f32_16x16x32_bf16 v[160:163], v[212:215], v[100:103], v[160:163]
    v_exp_f32 v150, v150
    v_mfma_f32_16x16x32_bf16 v[164:167], v[208:211], v[112:115], v[224:227]
    v_exp_f32 v151, v151
    v_mfma_f32_16x16x32_bf16 v[164:167], v[212:215], v[116:119], v[164:167]
    v_cvt_pk_bf16_f32 v179, v150, v151
    v_mfma_f32_16x16x32_bf16 v[172:175], v[208:211], v[128:131], v[228:231]
    ds_read_b128 v[208:211], v245 offset:46080
    v_mfma_f32_16x16x32_bf16 v[172:175], v[212:215], v[132:135], v[172:175]
    ds_read_b128 v[212:215], v244 offset:47104
    s_waitcnt lgkmcnt(3)
    v_mfma_f32_16x16x32_bf16 v[172:175], v[216:219], v[136:139], v[172:175]
    v_mfma_f32_16x16x32_bf16 v[172:175], v[200:203], v[140:143], v[172:175]
    v_mfma_f32_16x16x32_bf16 v[164:167], v[216:219], v[120:123], v[164:167]
    v_mfma_f32_16x16x32_bf16 v[164:167], v[200:203], v[124:127], v[164:167]
    v_mfma_f32_16x16x32_bf16 v[160:163], v[216:219], v[104:107], v[160:163]
    ds_read_b128 v[216:219], v245 offset:48128
    v_mfma_f32_16x16x32_bf16 v[160:163], v[200:203], v[108:111], v[160:163]
    ds_read_b128 v[200:203], v248 offset:32768
    s_waitcnt lgkmcnt(3)
    v_mfma_f32_16x16x32_bf16 v[144:147], v[204:207], v[96:99], v[220:223]
    v_exp_f32 v172, v172
    v_mfma_f32_16x16x32_bf16 v[144:147], v[208:211], v[100:103], v[144:147]
    v_exp_f32 v173, v173
    v_mfma_f32_16x16x32_bf16 v[168:171], v[204:207], v[112:115], v[224:227]
    v_exp_f32 v174, v174
    v_mfma_f32_16x16x32_bf16 v[168:171], v[208:211], v[116:119], v[168:171]
    v_exp_f32 v175, v175
    v_mfma_f32_16x16x32_bf16 v[156:159], v[204:207], v[128:131], v[228:231]
    ds_read_b128 v[204:207], v248 offset:33792
    v_cvt_pk_bf16_f32 v196, v172, v173
    v_mfma_f32_16x16x32_bf16 v[156:159], v[208:211], v[132:135], v[156:159]
    ds_read_b128 v[208:211], v248 offset:34816
    s_waitcnt lgkmcnt(3)
    v_mfma_f32_16x16x32_bf16 v[156:159], v[212:215], v[136:139], v[156:159]
    v_exp_f32 v164, v164
    v_mfma_f32_16x16x32_bf16 v[156:159], v[216:219], v[140:143], v[156:159]
    v_exp_f32 v165, v165
    v_mfma_f32_16x16x32_bf16 v[168:171], v[212:215], v[120:123], v[168:171]
    v_cvt_pk_bf16_f32 v197, v174, v175
    v_cvt_pk_bf16_f32 v188, v164, v165
    v_mfma_f32_16x16x32_bf16 v[168:171], v[216:219], v[124:127], v[168:171]
    v_exp_f32 v166, v166
    v_mfma_f32_16x16x32_bf16 v[144:147], v[212:215], v[104:107], v[144:147]
    ds_read_b128 v[212:215], v248 offset:35840
    v_mfma_f32_16x16x32_bf16 v[144:147], v[216:219], v[108:111], v[144:147]
    ds_read_b128 v[216:219], v248 offset:36864
    s_waitcnt lgkmcnt(3)
    v_smfmac_f32_16x16x64_bf16 v[232:235], v[240:243], v[176:183], v252
    v_mfma_f32_16x16x32_bf16 v[0:3], v[176:179], v[200:203], v[0:3]
    v_exp_f32 v167, v167
    v_mfma_f32_16x16x32_bf16 v[32:35], v[180:183], v[200:203], v[32:35]
    v_exp_f32 v160, v160
    v_mfma_f32_16x16x32_bf16 v[64:67], v[192:195], v[200:203], v[64:67]
    ds_read_b128 v[200:203], v248 offset:37888
    v_cvt_pk_bf16_f32 v189, v166, v167
    v_mfma_f32_16x16x32_bf16 v[4:7], v[176:179], v[204:207], v[4:7]
    v_exp_f32 v161, v161
    v_mfma_f32_16x16x32_bf16 v[36:39], v[180:183], v[204:207], v[36:39]
    v_exp_f32 v162, v162
    v_mfma_f32_16x16x32_bf16 v[68:71], v[192:195], v[204:207], v[68:71]
    ds_read_b128 v[204:207], v248 offset:38912
    s_waitcnt lgkmcnt(3)
    v_mfma_f32_16x16x32_bf16 v[8:11], v[176:179], v[208:211], v[8:11]
    v_exp_f32 v163, v163
    v_mfma_f32_16x16x32_bf16 v[40:43], v[180:183], v[208:211], v[40:43]
    v_cvt_pk_bf16_f32 v184, v160, v161
    v_cvt_pk_bf16_f32 v185, v162, v163
    v_mfma_f32_16x16x32_bf16 v[72:75], v[192:195], v[208:211], v[72:75]
    ds_read_b128 v[208:211], v248 offset:39936
    v_mfma_f32_16x16x32_bf16 v[12:15], v[176:179], v[212:215], v[12:15]
    v_exp_f32 v156, v156
    v_mfma_f32_16x16x32_bf16 v[44:47], v[180:183], v[212:215], v[44:47]
    v_exp_f32 v157, v157
    v_mfma_f32_16x16x32_bf16 v[76:79], v[192:195], v[212:215], v[76:79]
    ds_read_b128 v[212:215], v244 offset:49152
    s_waitcnt lgkmcnt(3)
    v_mfma_f32_16x16x32_bf16 v[16:19], v[176:179], v[216:219], v[16:19]
    v_exp_f32 v158, v158
    v_mfma_f32_16x16x32_bf16 v[48:51], v[180:183], v[216:219], v[48:51]
    v_exp_f32 v159, v159
    v_mfma_f32_16x16x32_bf16 v[80:83], v[192:195], v[216:219], v[80:83]
    ds_read_b128 v[216:219], v245 offset:50176
    v_cvt_pk_bf16_f32 v198, v156, v157
    v_mfma_f32_16x16x32_bf16 v[20:23], v[176:179], v[200:203], v[20:23]
    v_exp_f32 v168, v168
    v_mfma_f32_16x16x32_bf16 v[52:55], v[180:183], v[200:203], v[52:55]
    v_exp_f32 v169, v169
    v_mfma_f32_16x16x32_bf16 v[84:87], v[192:195], v[200:203], v[84:87]
    ds_read_b128 v[200:203], v244 offset:51200
    s_waitcnt lgkmcnt(3)
    v_mfma_f32_16x16x32_bf16 v[24:27], v[176:179], v[204:207], v[24:27]
    v_cvt_pk_bf16_f32 v199, v158, v159
    v_cvt_pk_bf16_f32 v190, v168, v169
    v_mfma_f32_16x16x32_bf16 v[56:59], v[180:183], v[204:207], v[56:59]
    v_exp_f32 v170, v170
    v_mfma_f32_16x16x32_bf16 v[88:91], v[192:195], v[204:207], v[88:91]
    ds_read_b128 v[204:207], v245 offset:52224
    v_mfma_f32_16x16x32_bf16 v[28:31], v[176:179], v[208:211], v[28:31]
    v_exp_f32 v171, v171
    v_mfma_f32_16x16x32_bf16 v[60:63], v[180:183], v[208:211], v[60:63]
    v_exp_f32 v144, v144
    v_mfma_f32_16x16x32_bf16 v[92:95], v[192:195], v[208:211], v[92:95]
    ds_read_b128 v[208:211], v244 offset:53248
    s_waitcnt lgkmcnt(3)
    v_mfma_f32_16x16x32_bf16 v[152:155], v[212:215], v[96:99], v[220:223]
    v_exp_f32 v145, v145
    v_mfma_f32_16x16x32_bf16 v[152:155], v[216:219], v[100:103], v[152:155]
    v_cvt_pk_bf16_f32 v191, v170, v171
    v_cvt_pk_bf16_f32 v186, v144, v145
    v_mfma_f32_16x16x32_bf16 v[148:151], v[212:215], v[112:115], v[224:227]
    v_exp_f32 v146, v146
    v_mfma_f32_16x16x32_bf16 v[148:151], v[216:219], v[116:119], v[148:151]
    v_exp_f32 v147, v147
    v_mfma_f32_16x16x32_bf16 v[172:175], v[212:215], v[128:131], v[228:231]
    ds_read_b128 v[212:215], v245 offset:54272
    v_cvt_pk_bf16_f32 v187, v146, v147
    v_mfma_f32_16x16x32_bf16 v[172:175], v[216:219], v[132:135], v[172:175]
    ds_read_b128 v[216:219], v244 offset:55296
    s_waitcnt lgkmcnt(3)
    v_mfma_f32_16x16x32_bf16 v[172:175], v[200:203], v[136:139], v[172:175]
    v_mfma_f32_16x16x32_bf16 v[172:175], v[204:207], v[140:143], v[172:175]
    v_mfma_f32_16x16x32_bf16 v[148:151], v[200:203], v[120:123], v[148:151]
    v_mfma_f32_16x16x32_bf16 v[148:151], v[204:207], v[124:127], v[148:151]
    v_mfma_f32_16x16x32_bf16 v[152:155], v[200:203], v[104:107], v[152:155]
    ds_read_b128 v[200:203], v245 offset:56320
    v_mfma_f32_16x16x32_bf16 v[152:155], v[204:207], v[108:111], v[152:155]
    ds_read_b128 v[204:207], v248 offset:40960
    s_waitcnt lgkmcnt(3)
    v_mfma_f32_16x16x32_bf16 v[164:167], v[208:211], v[96:99], v[220:223]
    v_exp_f32 v172, v172
    v_mfma_f32_16x16x32_bf16 v[164:167], v[212:215], v[100:103], v[164:167]
    v_exp_f32 v173, v173
    v_mfma_f32_16x16x32_bf16 v[160:163], v[208:211], v[112:115], v[224:227]
    v_exp_f32 v174, v174
    v_mfma_f32_16x16x32_bf16 v[160:163], v[212:215], v[116:119], v[160:163]
    v_exp_f32 v175, v175
    v_mfma_f32_16x16x32_bf16 v[156:159], v[208:211], v[128:131], v[228:231]
    ds_read_b128 v[208:211], v248 offset:41984
    v_mfma_f32_16x16x32_bf16 v[156:159], v[212:215], v[132:135], v[156:159]
    ds_read_b128 v[212:215], v248 offset:43008
    s_waitcnt lgkmcnt(3)
    v_mfma_f32_16x16x32_bf16 v[156:159], v[216:219], v[136:139], v[156:159]
    v_exp_f32 v148, v148
    v_mfma_f32_16x16x32_bf16 v[156:159], v[200:203], v[140:143], v[156:159]
    v_exp_f32 v149, v149
    v_mfma_f32_16x16x32_bf16 v[160:163], v[216:219], v[120:123], v[160:163]
    v_exp_f32 v150, v150
    v_mfma_f32_16x16x32_bf16 v[160:163], v[200:203], v[124:127], v[160:163]
    v_exp_f32 v151, v151
    v_mfma_f32_16x16x32_bf16 v[164:167], v[216:219], v[104:107], v[164:167]
    ds_read_b128 v[216:219], v248 offset:44032
    v_cvt_pk_bf16_f32 v180, v148, v149
    v_mfma_f32_16x16x32_bf16 v[164:167], v[200:203], v[108:111], v[164:167]
    ds_read_b128 v[200:203], v248 offset:45056
    s_waitcnt lgkmcnt(3)
    v_smfmac_f32_16x16x64_bf16 v[232:235], v[240:243], v[184:191], v252
    v_cvt_pk_bf16_f32 v181, v150, v151
    v_smfmac_f32_16x16x64_bf16 v[236:239], v[240:243], v[192:199], v252
    v_cvt_pk_bf16_f32 v192, v172, v173
    v_mfma_f32_16x16x32_bf16 v[0:3], v[184:187], v[204:207], v[0:3]
    v_exp_f32 v152, v152
    v_mfma_f32_16x16x32_bf16 v[32:35], v[188:191], v[204:207], v[32:35]
    v_exp_f32 v153, v153
    v_mfma_f32_16x16x32_bf16 v[64:67], v[196:199], v[204:207], v[64:67]
    ds_read_b128 v[204:207], v248 offset:46080
    v_cvt_pk_bf16_f32 v193, v174, v175
    v_mfma_f32_16x16x32_bf16 v[4:7], v[184:187], v[208:211], v[4:7]
    v_exp_f32 v154, v154
    v_mfma_f32_16x16x32_bf16 v[36:39], v[188:191], v[208:211], v[36:39]
    v_exp_f32 v155, v155
    v_mfma_f32_16x16x32_bf16 v[68:71], v[196:199], v[208:211], v[68:71]
    ds_read_b128 v[208:211], v248 offset:47104
    s_waitcnt lgkmcnt(3)
    v_mfma_f32_16x16x32_bf16 v[8:11], v[184:187], v[212:215], v[8:11]
    v_cvt_pk_bf16_f32 v176, v152, v153
    v_cvt_pk_bf16_f32 v177, v154, v155
    v_mfma_f32_16x16x32_bf16 v[40:43], v[188:191], v[212:215], v[40:43]
    v_exp_f32 v156, v156
    v_mfma_f32_16x16x32_bf16 v[72:75], v[196:199], v[212:215], v[72:75]
    ds_read_b128 v[212:215], v248 offset:48128
    v_mfma_f32_16x16x32_bf16 v[12:15], v[184:187], v[216:219], v[12:15]
    v_exp_f32 v157, v157
    v_mfma_f32_16x16x32_bf16 v[44:47], v[188:191], v[216:219], v[44:47]
    v_exp_f32 v158, v158
    v_mfma_f32_16x16x32_bf16 v[76:79], v[196:199], v[216:219], v[76:79]
    ds_read_b128 v[216:219], v244 offset:57344
    s_waitcnt lgkmcnt(3)
    v_mfma_f32_16x16x32_bf16 v[16:19], v[184:187], v[200:203], v[16:19]
    v_exp_f32 v159, v159
    v_mfma_f32_16x16x32_bf16 v[48:51], v[188:191], v[200:203], v[48:51]
    v_cvt_pk_bf16_f32 v194, v156, v157
    v_cvt_pk_bf16_f32 v195, v158, v159
    v_mfma_f32_16x16x32_bf16 v[80:83], v[196:199], v[200:203], v[80:83]
    ds_read_b128 v[200:203], v245 offset:58368
    v_mfma_f32_16x16x32_bf16 v[20:23], v[184:187], v[204:207], v[20:23]
    v_exp_f32 v160, v160
    v_mfma_f32_16x16x32_bf16 v[52:55], v[188:191], v[204:207], v[52:55]
    v_exp_f32 v161, v161
    v_mfma_f32_16x16x32_bf16 v[84:87], v[196:199], v[204:207], v[84:87]
    ds_read_b128 v[204:207], v244 offset:59392
    s_waitcnt lgkmcnt(3)
    v_mfma_f32_16x16x32_bf16 v[24:27], v[184:187], v[208:211], v[24:27]
    v_exp_f32 v162, v162
    v_mfma_f32_16x16x32_bf16 v[56:59], v[188:191], v[208:211], v[56:59]
    v_exp_f32 v163, v163
    v_mfma_f32_16x16x32_bf16 v[88:91], v[196:199], v[208:211], v[88:91]
    ds_read_b128 v[208:211], v245 offset:60416
    v_cvt_pk_bf16_f32 v182, v160, v161
    v_mfma_f32_16x16x32_bf16 v[28:31], v[184:187], v[212:215], v[28:31]
    v_exp_f32 v164, v164
    v_mfma_f32_16x16x32_bf16 v[60:63], v[188:191], v[212:215], v[60:63]
    v_exp_f32 v165, v165
    v_mfma_f32_16x16x32_bf16 v[92:95], v[196:199], v[212:215], v[92:95]
    ds_read_b128 v[212:215], v244 offset:61440
    s_waitcnt lgkmcnt(3)
    v_mfma_f32_16x16x32_bf16 v[168:171], v[216:219], v[96:99], v[220:223]
    v_cvt_pk_bf16_f32 v183, v162, v163
    v_cvt_pk_bf16_f32 v178, v164, v165
    v_mfma_f32_16x16x32_bf16 v[168:171], v[200:203], v[100:103], v[168:171]
    v_exp_f32 v166, v166
    v_mfma_f32_16x16x32_bf16 v[144:147], v[216:219], v[112:115], v[224:227]
    v_exp_f32 v167, v167
    v_mfma_f32_16x16x32_bf16 v[144:147], v[200:203], v[116:119], v[144:147]
    v_cvt_pk_bf16_f32 v179, v166, v167
    v_mfma_f32_16x16x32_bf16 v[148:151], v[216:219], v[128:131], v[228:231]
    ds_read_b128 v[216:219], v245 offset:62464
    v_mfma_f32_16x16x32_bf16 v[148:151], v[200:203], v[132:135], v[148:151]
    ds_read_b128 v[200:203], v244 offset:63488
    s_waitcnt lgkmcnt(3)
    v_mfma_f32_16x16x32_bf16 v[148:151], v[204:207], v[136:139], v[148:151]
    v_mfma_f32_16x16x32_bf16 v[148:151], v[208:211], v[140:143], v[148:151]
    v_mfma_f32_16x16x32_bf16 v[144:147], v[204:207], v[120:123], v[144:147]
    v_mfma_f32_16x16x32_bf16 v[144:147], v[208:211], v[124:127], v[144:147]
    v_mfma_f32_16x16x32_bf16 v[168:171], v[204:207], v[104:107], v[168:171]
    ds_read_b128 v[204:207], v245 offset:64512
    v_mfma_f32_16x16x32_bf16 v[168:171], v[208:211], v[108:111], v[168:171]
    ds_read_b128 v[208:211], v248 offset:49152
    s_waitcnt lgkmcnt(3)
    v_mfma_f32_16x16x32_bf16 v[172:175], v[212:215], v[96:99], v[220:223]
    v_exp_f32 v148, v148
    v_mfma_f32_16x16x32_bf16 v[172:175], v[216:219], v[100:103], v[172:175]
    v_exp_f32 v149, v149
    v_mfma_f32_16x16x32_bf16 v[152:155], v[212:215], v[112:115], v[224:227]
    v_exp_f32 v150, v150
    v_mfma_f32_16x16x32_bf16 v[152:155], v[216:219], v[116:119], v[152:155]
    v_exp_f32 v151, v151
    v_mfma_f32_16x16x32_bf16 v[156:159], v[212:215], v[128:131], v[228:231]
    ds_read_b128 v[212:215], v248 offset:50176
    v_cvt_pk_bf16_f32 v196, v148, v149
    v_mfma_f32_16x16x32_bf16 v[156:159], v[216:219], v[132:135], v[156:159]
    ds_read_b128 v[216:219], v248 offset:51200
    s_waitcnt lgkmcnt(3)
    v_mfma_f32_16x16x32_bf16 v[156:159], v[200:203], v[136:139], v[156:159]
    v_exp_f32 v144, v144
    v_mfma_f32_16x16x32_bf16 v[156:159], v[204:207], v[140:143], v[156:159]
    v_exp_f32 v145, v145
    v_mfma_f32_16x16x32_bf16 v[152:155], v[200:203], v[120:123], v[152:155]
    v_cvt_pk_bf16_f32 v197, v150, v151
    v_cvt_pk_bf16_f32 v188, v144, v145
    v_mfma_f32_16x16x32_bf16 v[152:155], v[204:207], v[124:127], v[152:155]
    v_exp_f32 v146, v146
    v_mfma_f32_16x16x32_bf16 v[172:175], v[200:203], v[104:107], v[172:175]
    ds_read_b128 v[200:203], v248 offset:52224
    v_mfma_f32_16x16x32_bf16 v[172:175], v[204:207], v[108:111], v[172:175]
    ds_read_b128 v[204:207], v248 offset:53248
    s_waitcnt lgkmcnt(3)
    v_smfmac_f32_16x16x64_bf16 v[232:235], v[240:243], v[176:183], v252
    v_mfma_f32_16x16x32_bf16 v[0:3], v[176:179], v[208:211], v[0:3]
    v_exp_f32 v147, v147
    v_mfma_f32_16x16x32_bf16 v[32:35], v[180:183], v[208:211], v[32:35]
    v_exp_f32 v168, v168
    v_mfma_f32_16x16x32_bf16 v[64:67], v[192:195], v[208:211], v[64:67]
    ds_read_b128 v[208:211], v248 offset:54272
    v_cvt_pk_bf16_f32 v189, v146, v147
    v_mfma_f32_16x16x32_bf16 v[4:7], v[176:179], v[212:215], v[4:7]
    v_exp_f32 v169, v169
    v_mfma_f32_16x16x32_bf16 v[36:39], v[180:183], v[212:215], v[36:39]
    v_exp_f32 v170, v170
    v_mfma_f32_16x16x32_bf16 v[68:71], v[192:195], v[212:215], v[68:71]
    ds_read_b128 v[212:215], v248 offset:55296
    s_waitcnt lgkmcnt(3)
    v_mfma_f32_16x16x32_bf16 v[8:11], v[176:179], v[216:219], v[8:11]
    v_exp_f32 v171, v171
    v_mfma_f32_16x16x32_bf16 v[40:43], v[180:183], v[216:219], v[40:43]
    v_cvt_pk_bf16_f32 v184, v168, v169
    v_cvt_pk_bf16_f32 v185, v170, v171
    v_mfma_f32_16x16x32_bf16 v[72:75], v[192:195], v[216:219], v[72:75]
    ds_read_b128 v[216:219], v248 offset:56320
    v_mfma_f32_16x16x32_bf16 v[12:15], v[176:179], v[200:203], v[12:15]
    v_exp_f32 v156, v156
    v_mfma_f32_16x16x32_bf16 v[44:47], v[180:183], v[200:203], v[44:47]
    v_exp_f32 v157, v157
    v_mfma_f32_16x16x32_bf16 v[76:79], v[192:195], v[200:203], v[76:79]
    ds_read_b128 v[200:203], v246 offset:0
    s_waitcnt lgkmcnt(3)
    v_mfma_f32_16x16x32_bf16 v[16:19], v[176:179], v[204:207], v[16:19]
    v_exp_f32 v158, v158
    v_mfma_f32_16x16x32_bf16 v[48:51], v[180:183], v[204:207], v[48:51]
    v_exp_f32 v159, v159
    v_mfma_f32_16x16x32_bf16 v[80:83], v[192:195], v[204:207], v[80:83]
    ds_read_b128 v[204:207], v247 offset:1024
    v_cvt_pk_bf16_f32 v198, v156, v157
    v_mfma_f32_16x16x32_bf16 v[20:23], v[176:179], v[208:211], v[20:23]
    v_exp_f32 v152, v152
    v_mfma_f32_16x16x32_bf16 v[52:55], v[180:183], v[208:211], v[52:55]
    v_exp_f32 v153, v153
    v_mfma_f32_16x16x32_bf16 v[84:87], v[192:195], v[208:211], v[84:87]
    ds_read_b128 v[208:211], v246 offset:2048
    s_waitcnt lgkmcnt(3)
    v_mfma_f32_16x16x32_bf16 v[24:27], v[176:179], v[212:215], v[24:27]
    v_cvt_pk_bf16_f32 v199, v158, v159
    v_cvt_pk_bf16_f32 v190, v152, v153
    v_mfma_f32_16x16x32_bf16 v[56:59], v[180:183], v[212:215], v[56:59]
    v_exp_f32 v154, v154
    v_mfma_f32_16x16x32_bf16 v[88:91], v[192:195], v[212:215], v[88:91]
    ds_read_b128 v[212:215], v247 offset:3072
    v_mfma_f32_16x16x32_bf16 v[28:31], v[176:179], v[216:219], v[28:31]
    v_exp_f32 v155, v155
    v_mfma_f32_16x16x32_bf16 v[60:63], v[180:183], v[216:219], v[60:63]
    v_exp_f32 v172, v172
    v_mfma_f32_16x16x32_bf16 v[92:95], v[192:195], v[216:219], v[92:95]
    ds_read_b128 v[216:219], v246 offset:4096
    s_waitcnt lgkmcnt(3)
    s_setprio 3
    v_mfma_f32_16x16x32_bf16 v[160:163], v[200:203], v[96:99], v[220:223]
    v_exp_f32 v173, v173
    v_mfma_f32_16x16x32_bf16 v[160:163], v[204:207], v[100:103], v[160:163]
    v_cvt_pk_bf16_f32 v191, v154, v155
    v_cvt_pk_bf16_f32 v186, v172, v173
    v_mfma_f32_16x16x32_bf16 v[164:167], v[200:203], v[112:115], v[224:227]
    v_exp_f32 v174, v174
    v_mfma_f32_16x16x32_bf16 v[164:167], v[204:207], v[116:119], v[164:167]
    v_exp_f32 v175, v175
    v_mfma_f32_16x16x32_bf16 v[148:151], v[200:203], v[128:131], v[228:231]
    ds_read_b128 v[200:203], v247 offset:5120
    v_cvt_pk_bf16_f32 v187, v174, v175
    v_mfma_f32_16x16x32_bf16 v[148:151], v[204:207], v[132:135], v[148:151]
    ds_read_b128 v[204:207], v246 offset:6144
    s_waitcnt lgkmcnt(3)
    v_mfma_f32_16x16x32_bf16 v[148:151], v[208:211], v[136:139], v[148:151]
    v_mfma_f32_16x16x32_bf16 v[148:151], v[212:215], v[140:143], v[148:151]
    v_mfma_f32_16x16x32_bf16 v[164:167], v[208:211], v[120:123], v[164:167]
    v_mfma_f32_16x16x32_bf16 v[164:167], v[212:215], v[124:127], v[164:167]
    v_mfma_f32_16x16x32_bf16 v[160:163], v[208:211], v[104:107], v[160:163]
    ds_read_b128 v[208:211], v247 offset:7168
    v_mfma_f32_16x16x32_bf16 v[160:163], v[212:215], v[108:111], v[160:163]
    ds_read_b128 v[212:215], v248 offset:57344
    s_waitcnt lgkmcnt(3)
    v_mfma_f32_16x16x32_bf16 v[144:147], v[216:219], v[96:99], v[220:223]
    v_exp_f32 v148, v148
    v_mfma_f32_16x16x32_bf16 v[144:147], v[200:203], v[100:103], v[144:147]
    v_exp_f32 v149, v149
    v_mfma_f32_16x16x32_bf16 v[168:171], v[216:219], v[112:115], v[224:227]
    v_exp_f32 v150, v150
    v_mfma_f32_16x16x32_bf16 v[168:171], v[200:203], v[116:119], v[168:171]
    v_exp_f32 v151, v151
    v_mfma_f32_16x16x32_bf16 v[156:159], v[216:219], v[128:131], v[228:231]
    ds_read_b128 v[216:219], v248 offset:58368
    v_mfma_f32_16x16x32_bf16 v[156:159], v[200:203], v[132:135], v[156:159]
    ds_read_b128 v[200:203], v248 offset:59392
    s_waitcnt lgkmcnt(3)
    v_mfma_f32_16x16x32_bf16 v[156:159], v[204:207], v[136:139], v[156:159]
    v_exp_f32 v164, v164
    v_mfma_f32_16x16x32_bf16 v[156:159], v[208:211], v[140:143], v[156:159]
    v_exp_f32 v165, v165
    v_mfma_f32_16x16x32_bf16 v[168:171], v[204:207], v[120:123], v[168:171]
    v_exp_f32 v166, v166
    v_mfma_f32_16x16x32_bf16 v[168:171], v[208:211], v[124:127], v[168:171]
    v_exp_f32 v167, v167
    v_mfma_f32_16x16x32_bf16 v[144:147], v[204:207], v[104:107], v[144:147]
    ds_read_b128 v[204:207], v248 offset:60416
    v_cvt_pk_bf16_f32 v180, v164, v165
    v_mfma_f32_16x16x32_bf16 v[144:147], v[208:211], v[108:111], v[144:147]
    ds_read_b128 v[208:211], v248 offset:61440
    s_waitcnt lgkmcnt(3)
    v_smfmac_f32_16x16x64_bf16 v[232:235], v[240:243], v[184:191], v252
    v_cvt_pk_bf16_f32 v181, v166, v167
    v_smfmac_f32_16x16x64_bf16 v[236:239], v[240:243], v[192:199], v252
    v_cvt_pk_bf16_f32 v192, v148, v149
    v_mfma_f32_16x16x32_bf16 v[0:3], v[184:187], v[212:215], v[0:3]
    v_exp_f32 v160, v160
    v_mfma_f32_16x16x32_bf16 v[32:35], v[188:191], v[212:215], v[32:35]
    v_exp_f32 v161, v161
    v_mfma_f32_16x16x32_bf16 v[64:67], v[196:199], v[212:215], v[64:67]
    ds_read_b128 v[212:215], v248 offset:62464
    v_cvt_pk_bf16_f32 v193, v150, v151
    v_mfma_f32_16x16x32_bf16 v[4:7], v[184:187], v[216:219], v[4:7]
    v_exp_f32 v162, v162
    v_mfma_f32_16x16x32_bf16 v[36:39], v[188:191], v[216:219], v[36:39]
    v_exp_f32 v163, v163
    v_mfma_f32_16x16x32_bf16 v[68:71], v[196:199], v[216:219], v[68:71]
    ds_read_b128 v[216:219], v248 offset:63488
    s_waitcnt lgkmcnt(3)
    v_mfma_f32_16x16x32_bf16 v[8:11], v[184:187], v[200:203], v[8:11]
    v_cvt_pk_bf16_f32 v176, v160, v161
    v_cvt_pk_bf16_f32 v177, v162, v163
    v_mfma_f32_16x16x32_bf16 v[40:43], v[188:191], v[200:203], v[40:43]
    v_exp_f32 v156, v156
    v_mfma_f32_16x16x32_bf16 v[72:75], v[196:199], v[200:203], v[72:75]
    ds_read_b128 v[200:203], v248 offset:64512
    v_mfma_f32_16x16x32_bf16 v[12:15], v[184:187], v[204:207], v[12:15]
    v_exp_f32 v157, v157
    v_mfma_f32_16x16x32_bf16 v[44:47], v[188:191], v[204:207], v[44:47]
    v_exp_f32 v158, v158
    v_mfma_f32_16x16x32_bf16 v[76:79], v[196:199], v[204:207], v[76:79]
    ds_read_b128 v[204:207], v246 offset:8192
    s_waitcnt lgkmcnt(3)
    v_mfma_f32_16x16x32_bf16 v[16:19], v[184:187], v[208:211], v[16:19]
    v_exp_f32 v159, v159
    v_mfma_f32_16x16x32_bf16 v[48:51], v[188:191], v[208:211], v[48:51]
    v_cvt_pk_bf16_f32 v194, v156, v157
    v_cvt_pk_bf16_f32 v195, v158, v159
    v_mfma_f32_16x16x32_bf16 v[80:83], v[196:199], v[208:211], v[80:83]
    ds_read_b128 v[208:211], v247 offset:9216
    v_mfma_f32_16x16x32_bf16 v[20:23], v[184:187], v[212:215], v[20:23]
    v_exp_f32 v168, v168
    v_mfma_f32_16x16x32_bf16 v[52:55], v[188:191], v[212:215], v[52:55]
    v_exp_f32 v169, v169
    v_mfma_f32_16x16x32_bf16 v[84:87], v[196:199], v[212:215], v[84:87]
    ds_read_b128 v[212:215], v246 offset:10240
    s_waitcnt lgkmcnt(3)
    v_mfma_f32_16x16x32_bf16 v[24:27], v[184:187], v[216:219], v[24:27]
    v_exp_f32 v170, v170
    v_mfma_f32_16x16x32_bf16 v[56:59], v[188:191], v[216:219], v[56:59]
    v_exp_f32 v171, v171
    v_mfma_f32_16x16x32_bf16 v[88:91], v[196:199], v[216:219], v[88:91]
    ds_read_b128 v[216:219], v247 offset:11264
    v_cvt_pk_bf16_f32 v182, v168, v169
    v_mfma_f32_16x16x32_bf16 v[28:31], v[184:187], v[200:203], v[28:31]
    v_exp_f32 v144, v144
    v_mfma_f32_16x16x32_bf16 v[60:63], v[188:191], v[200:203], v[60:63]
    v_exp_f32 v145, v145
    v_mfma_f32_16x16x32_bf16 v[92:95], v[196:199], v[200:203], v[92:95]
    ds_read_b128 v[200:203], v246 offset:12288
    s_waitcnt lgkmcnt(3)
    v_mfma_f32_16x16x32_bf16 v[152:155], v[204:207], v[96:99], v[220:223]
    v_cvt_pk_bf16_f32 v183, v170, v171
    v_cvt_pk_bf16_f32 v178, v144, v145
    v_mfma_f32_16x16x32_bf16 v[152:155], v[208:211], v[100:103], v[152:155]
    v_exp_f32 v146, v146
    v_mfma_f32_16x16x32_bf16 v[172:175], v[204:207], v[112:115], v[224:227]
    v_exp_f32 v147, v147
    v_mfma_f32_16x16x32_bf16 v[172:175], v[208:211], v[116:119], v[172:175]
    v_cvt_pk_bf16_f32 v179, v146, v147
    v_mfma_f32_16x16x32_bf16 v[164:167], v[204:207], v[128:131], v[228:231]
    ds_read_b128 v[204:207], v247 offset:13312
    v_mfma_f32_16x16x32_bf16 v[164:167], v[208:211], v[132:135], v[164:167]
    ds_read_b128 v[208:211], v246 offset:14336
    s_waitcnt lgkmcnt(3)
    v_mfma_f32_16x16x32_bf16 v[164:167], v[212:215], v[136:139], v[164:167]
    v_mfma_f32_16x16x32_bf16 v[164:167], v[216:219], v[140:143], v[164:167]
    v_mfma_f32_16x16x32_bf16 v[172:175], v[212:215], v[120:123], v[172:175]
    v_mfma_f32_16x16x32_bf16 v[172:175], v[216:219], v[124:127], v[172:175]
    v_mfma_f32_16x16x32_bf16 v[152:155], v[212:215], v[104:107], v[152:155]
    ds_read_b128 v[212:215], v247 offset:15360
    v_mfma_f32_16x16x32_bf16 v[152:155], v[216:219], v[108:111], v[152:155]
    ds_read_b128 v[216:219], v249 offset:0
    s_waitcnt lgkmcnt(3)
    v_mfma_f32_16x16x32_bf16 v[148:151], v[200:203], v[96:99], v[220:223]
    v_exp_f32 v164, v164
    v_mfma_f32_16x16x32_bf16 v[148:151], v[204:207], v[100:103], v[148:151]
    v_exp_f32 v165, v165
    v_mfma_f32_16x16x32_bf16 v[160:163], v[200:203], v[112:115], v[224:227]
    v_exp_f32 v166, v166
    v_mfma_f32_16x16x32_bf16 v[160:163], v[204:207], v[116:119], v[160:163]
    v_exp_f32 v167, v167
    v_mfma_f32_16x16x32_bf16 v[156:159], v[200:203], v[128:131], v[228:231]
    ds_read_b128 v[200:203], v249 offset:1024
    v_cvt_pk_bf16_f32 v196, v164, v165
    v_mfma_f32_16x16x32_bf16 v[156:159], v[204:207], v[132:135], v[156:159]
    ds_read_b128 v[204:207], v249 offset:2048
    s_waitcnt lgkmcnt(3)
    v_mfma_f32_16x16x32_bf16 v[156:159], v[208:211], v[136:139], v[156:159]
    v_exp_f32 v172, v172
    v_mfma_f32_16x16x32_bf16 v[156:159], v[212:215], v[140:143], v[156:159]
    v_exp_f32 v173, v173
    v_mfma_f32_16x16x32_bf16 v[160:163], v[208:211], v[120:123], v[160:163]
    v_cvt_pk_bf16_f32 v197, v166, v167
    v_cvt_pk_bf16_f32 v188, v172, v173
    v_mfma_f32_16x16x32_bf16 v[160:163], v[212:215], v[124:127], v[160:163]
    v_exp_f32 v174, v174
    v_mfma_f32_16x16x32_bf16 v[148:151], v[208:211], v[104:107], v[148:151]
    ds_read_b128 v[208:211], v249 offset:3072
    v_mfma_f32_16x16x32_bf16 v[148:151], v[212:215], v[108:111], v[148:151]
    ds_read_b128 v[212:215], v249 offset:4096
    s_waitcnt lgkmcnt(3)
    v_smfmac_f32_16x16x64_bf16 v[232:235], v[240:243], v[176:183], v252
    buffer_load_dwordx4 v[96:99], v250, s[64:67], s26 offen offset:0 nt
    v_mfma_f32_16x16x32_bf16 v[0:3], v[176:179], v[216:219], v[0:3]
    v_exp_f32 v175, v175
    v_mfma_f32_16x16x32_bf16 v[32:35], v[180:183], v[216:219], v[32:35]
    v_exp_f32 v152, v152
    v_mfma_f32_16x16x32_bf16 v[64:67], v[192:195], v[216:219], v[64:67]
    ds_read_b128 v[216:219], v249 offset:5120
    buffer_load_dwordx4 v[100:103], v250, s[64:67], s26 offen offset:64 nt
    v_mfma_f32_16x16x32_bf16 v[4:7], v[176:179], v[200:203], v[4:7]
    v_exp_f32 v153, v153
    v_mfma_f32_16x16x32_bf16 v[36:39], v[180:183], v[200:203], v[36:39]
    v_cvt_pk_bf16_f32 v189, v174, v175
    v_cvt_pk_bf16_f32 v184, v152, v153
    v_mfma_f32_16x16x32_bf16 v[68:71], v[192:195], v[200:203], v[68:71]
    ds_read_b128 v[200:203], v249 offset:6144
    s_waitcnt lgkmcnt(3)
    v_mfma_f32_16x16x32_bf16 v[8:11], v[176:179], v[204:207], v[8:11]
    v_exp_f32 v154, v154
    v_mfma_f32_16x16x32_bf16 v[40:43], v[180:183], v[204:207], v[40:43]
    v_exp_f32 v155, v155
    v_mfma_f32_16x16x32_bf16 v[72:75], v[192:195], v[204:207], v[72:75]
    ds_read_b128 v[204:207], v249 offset:7168
    buffer_load_dwordx4 v[112:115], v250, s[64:67], s27 offen offset:0 nt
    v_mfma_f32_16x16x32_bf16 v[12:15], v[176:179], v[208:211], v[12:15]
    v_exp_f32 v156, v156
    v_mfma_f32_16x16x32_bf16 v[44:47], v[180:183], v[208:211], v[44:47]
    v_exp_f32 v157, v157
    v_mfma_f32_16x16x32_bf16 v[76:79], v[192:195], v[208:211], v[76:79]
    ds_read_b128 v[208:211], v249 offset:8192
    s_waitcnt lgkmcnt(3)
    v_mfma_f32_16x16x32_bf16 v[16:19], v[176:179], v[212:215], v[16:19]
    v_cvt_pk_bf16_f32 v185, v154, v155
    v_cvt_pk_bf16_f32 v198, v156, v157
    v_mfma_f32_16x16x32_bf16 v[48:51], v[180:183], v[212:215], v[48:51]
    v_exp_f32 v158, v158
    v_mfma_f32_16x16x32_bf16 v[80:83], v[192:195], v[212:215], v[80:83]
    ds_read_b128 v[212:215], v249 offset:9216
    buffer_load_dwordx4 v[116:119], v250, s[64:67], s27 offen offset:64 nt
    v_mfma_f32_16x16x32_bf16 v[20:23], v[176:179], v[216:219], v[20:23]
    v_exp_f32 v159, v159
    v_mfma_f32_16x16x32_bf16 v[52:55], v[180:183], v[216:219], v[52:55]
    v_exp_f32 v160, v160
    v_mfma_f32_16x16x32_bf16 v[84:87], v[192:195], v[216:219], v[84:87]
    ds_read_b128 v[216:219], v249 offset:10240
    s_waitcnt lgkmcnt(3)
    v_mfma_f32_16x16x32_bf16 v[24:27], v[176:179], v[200:203], v[24:27]
    v_exp_f32 v161, v161
    v_mfma_f32_16x16x32_bf16 v[56:59], v[180:183], v[200:203], v[56:59]
    v_cvt_pk_bf16_f32 v199, v158, v159
    v_cvt_pk_bf16_f32 v190, v160, v161
    v_mfma_f32_16x16x32_bf16 v[88:91], v[192:195], v[200:203], v[88:91]
    ds_read_b128 v[200:203], v249 offset:11264
    buffer_load_dwordx4 v[104:107], v250, s[64:67], s26 offen offset:128 nt
    v_mfma_f32_16x16x32_bf16 v[28:31], v[176:179], v[204:207], v[28:31]
    v_exp_f32 v162, v162
    v_mfma_f32_16x16x32_bf16 v[60:63], v[180:183], v[204:207], v[60:63]
    v_exp_f32 v163, v163
    v_mfma_f32_16x16x32_bf16 v[92:95], v[192:195], v[204:207], v[92:95]
    ds_read_b128 v[204:207], v249 offset:12288
    s_waitcnt lgkmcnt(3)
    v_cvt_pk_bf16_f32 v191, v162, v163
    v_exp_f32 v148, v148
    v_exp_f32 v149, v149
    v_exp_f32 v150, v150
    v_cvt_pk_bf16_f32 v186, v148, v149
    v_exp_f32 v151, v151
    s_nop 0
    v_cvt_pk_bf16_f32 v187, v150, v151
    s_nop 1
    v_smfmac_f32_16x16x64_bf16 v[232:235], v[240:243], v[184:191], v252
    buffer_load_dwordx4 v[108:111], v250, s[64:67], s26 offen offset:192 nt
    v_smfmac_f32_16x16x64_bf16 v[236:239], v[240:243], v[192:199], v252
    v_mfma_f32_16x16x32_bf16 v[0:3], v[184:187], v[208:211], v[0:3]
    v_mfma_f32_16x16x32_bf16 v[32:35], v[188:191], v[208:211], v[32:35]
    buffer_load_dwordx4 v[120:123], v250, s[64:67], s27 offen offset:128 nt
    v_mfma_f32_16x16x32_bf16 v[64:67], v[196:199], v[208:211], v[64:67]
    ds_read_b128 v[208:211], v249 offset:13312
    v_mfma_f32_16x16x32_bf16 v[4:7], v[184:187], v[212:215], v[4:7]
    v_add_f32 v232, v232, v233
    v_add_f32 v234, v234, v235
    v_mfma_f32_16x16x32_bf16 v[36:39], v[188:191], v[212:215], v[36:39]
    v_add_f32 v236, v236, v237
    v_add_f32 v238, v238, v239
    v_mfma_f32_16x16x32_bf16 v[68:71], v[196:199], v[212:215], v[68:71]
    ds_read_b128 v[212:215], v249 offset:14336
    s_waitcnt lgkmcnt(3)
    v_mfma_f32_16x16x32_bf16 v[8:11], v[184:187], v[216:219], v[8:11]
    v_add_f32 v236, v236, v238
    v_add_f32 v176, v232, v234
    v_mfma_f32_16x16x32_bf16 v[40:43], v[188:191], v[216:219], v[40:43]
    v_rcp_f32 v237, v236
    v_mfma_f32_16x16x32_bf16 v[72:75], v[196:199], v[216:219], v[72:75]
    ds_read_b128 v[216:219], v249 offset:15360
    buffer_load_dwordx4 v[124:127], v250, s[64:67], s27 offen offset:192 nt
    v_mfma_f32_16x16x32_bf16 v[12:15], v[184:187], v[200:203], v[12:15]
    v_rcp_f32 v233, v232
    v_mfma_f32_16x16x32_bf16 v[44:47], v[188:191], v[200:203], v[44:47]
    v_rcp_f32 v235, v234
    v_mfma_f32_16x16x32_bf16 v[76:79], v[196:199], v[200:203], v[76:79]
    ds_read_b128 v[200:203], v244 offset:0
    s_waitcnt lgkmcnt(3)
    v_add_f32 v176, v176, v236
    v_cmp_nge_f32 vcc, s40, v176
    v_mfma_f32_16x16x32_bf16 v[16:19], v[184:187], v[204:207], v[16:19]
    ds_bpermute_b32 v220, v253, v233 offset:0
    v_mfma_f32_16x16x32_bf16 v[48:51], v[188:191], v[204:207], v[48:51]
    ds_bpermute_b32 v221, v253, v233 offset:4
    v_mfma_f32_16x16x32_bf16 v[80:83], v[196:199], v[204:207], v[80:83]
    ds_read_b128 v[204:207], v245 offset:1024
    v_mfma_f32_16x16x32_bf16 v[20:23], v[184:187], v[208:211], v[20:23]
    ds_bpermute_b32 v222, v253, v233 offset:8
    v_mfma_f32_16x16x32_bf16 v[52:55], v[188:191], v[208:211], v[52:55]
    ds_bpermute_b32 v223, v253, v233 offset:12
    v_mfma_f32_16x16x32_bf16 v[84:87], v[196:199], v[208:211], v[84:87]
    ds_read_b128 v[208:211], v244 offset:2048
    s_waitcnt lgkmcnt(7)
    v_mfma_f32_16x16x32_bf16 v[24:27], v[184:187], v[212:215], v[24:27]
    ds_bpermute_b32 v224, v253, v235 offset:0
    v_mfma_f32_16x16x32_bf16 v[56:59], v[188:191], v[212:215], v[56:59]
    ds_bpermute_b32 v225, v253, v235 offset:4
    v_mfma_f32_16x16x32_bf16 v[88:91], v[196:199], v[212:215], v[88:91]
    ds_read_b128 v[212:215], v245 offset:3072
    v_mfma_f32_16x16x32_bf16 v[28:31], v[184:187], v[216:219], v[28:31]
    ds_bpermute_b32 v226, v253, v235 offset:8
    v_mfma_f32_16x16x32_bf16 v[60:63], v[188:191], v[216:219], v[60:63]
    ds_bpermute_b32 v227, v253, v235 offset:12
    v_mfma_f32_16x16x32_bf16 v[92:95], v[196:199], v[216:219], v[92:95]
    ds_read_b128 v[216:219], v244 offset:4096
    s_waitcnt lgkmcnt(9)
    ds_bpermute_b32 v228, v253, v237 offset:0
    ds_bpermute_b32 v229, v253, v237 offset:4
    ds_bpermute_b32 v230, v253, v237 offset:8
    ds_bpermute_b32 v231, v253, v237 offset:12
    s_setprio 0
    v_mul_f32 v0, v220, v0
    v_mul_f32 v4, v220, v4
    v_mul_f32 v8, v220, v8
    v_mul_f32 v12, v220, v12
    v_mul_f32 v16, v220, v16
    v_mul_f32 v20, v220, v20
    v_mul_f32 v24, v220, v24
    v_mul_f32 v28, v220, v28
    v_cvt_pk_bf16_f32 v144, v0, v4
    v_cvt_pk_bf16_f32 v145, v8, v12
    v_cvt_pk_bf16_f32 v146, v16, v20
    v_cvt_pk_bf16_f32 v147, v24, v28
    buffer_store_dwordx4 v[144:147], v251, s[20:23], s37 offen offset:0 sc0 sc1 nt
    v_mul_f32 v1, v221, v1
    v_mul_f32 v5, v221, v5
    v_mul_f32 v9, v221, v9
    v_mul_f32 v13, v221, v13
    v_mul_f32 v17, v221, v17
    v_mul_f32 v21, v221, v21
    v_mul_f32 v25, v221, v25
    v_mul_f32 v29, v221, v29
    v_cvt_pk_bf16_f32 v148, v1, v5
    v_cvt_pk_bf16_f32 v149, v9, v13
    v_cvt_pk_bf16_f32 v150, v17, v21
    v_cvt_pk_bf16_f32 v151, v25, v29
    buffer_store_dwordx4 v[148:151], v251, s[20:23], s37 offen offset:256 sc0 sc1 nt
    s_waitcnt lgkmcnt(12)
    v_mul_f32 v2, v222, v2
    v_mul_f32 v6, v222, v6
    v_mul_f32 v10, v222, v10
    v_mul_f32 v14, v222, v14
    v_mul_f32 v18, v222, v18
    v_mul_f32 v22, v222, v22
    v_mul_f32 v26, v222, v26
    v_mul_f32 v30, v222, v30
    v_cvt_pk_bf16_f32 v152, v2, v6
    v_cvt_pk_bf16_f32 v153, v10, v14
    v_cvt_pk_bf16_f32 v154, v18, v22
    v_cvt_pk_bf16_f32 v155, v26, v30
    buffer_store_dwordx4 v[152:155], v251, s[20:23], s37 offen offset:512 sc0 sc1 nt
    s_waitcnt lgkmcnt(11)
    v_mul_f32 v3, v223, v3
    v_mul_f32 v7, v223, v7
    v_mul_f32 v11, v223, v11
    v_mul_f32 v15, v223, v15
    v_mul_f32 v19, v223, v19
    v_mul_f32 v23, v223, v23
    v_mul_f32 v27, v223, v27
    v_mul_f32 v31, v223, v31
    v_cvt_pk_bf16_f32 v156, v3, v7
    v_cvt_pk_bf16_f32 v157, v11, v15
    v_cvt_pk_bf16_f32 v158, v19, v23
    v_cvt_pk_bf16_f32 v159, v27, v31
    buffer_store_dwordx4 v[156:159], v251, s[20:23], s37 offen offset:768 sc0 sc1 nt
    s_waitcnt lgkmcnt(9)
    v_mul_f32 v32, v224, v32
    v_mul_f32 v36, v224, v36
    v_mul_f32 v40, v224, v40
    v_mul_f32 v44, v224, v44
    v_mul_f32 v48, v224, v48
    v_mul_f32 v52, v224, v52
    v_mul_f32 v56, v224, v56
    v_mul_f32 v60, v224, v60
    v_cvt_pk_bf16_f32 v160, v32, v36
    v_cvt_pk_bf16_f32 v161, v40, v44
    v_cvt_pk_bf16_f32 v162, v48, v52
    v_cvt_pk_bf16_f32 v163, v56, v60
    buffer_store_dwordx4 v[160:163], v251, s[20:23], s38 offen offset:0 sc0 sc1 nt
    s_waitcnt lgkmcnt(8)
    v_mul_f32 v33, v225, v33
    v_mul_f32 v37, v225, v37
    v_mul_f32 v41, v225, v41
    v_mul_f32 v45, v225, v45
    v_mul_f32 v49, v225, v49
    v_mul_f32 v53, v225, v53
    v_mul_f32 v57, v225, v57
    v_mul_f32 v61, v225, v61
    v_cvt_pk_bf16_f32 v164, v33, v37
    v_cvt_pk_bf16_f32 v165, v41, v45
    v_cvt_pk_bf16_f32 v166, v49, v53
    v_cvt_pk_bf16_f32 v167, v57, v61
    buffer_store_dwordx4 v[164:167], v251, s[20:23], s38 offen offset:256 sc0 sc1 nt
    s_waitcnt lgkmcnt(6)
    v_mul_f32 v34, v226, v34
    v_mul_f32 v38, v226, v38
    v_mul_f32 v42, v226, v42
    v_mul_f32 v46, v226, v46
    v_mul_f32 v50, v226, v50
    v_mul_f32 v54, v226, v54
    v_mul_f32 v58, v226, v58
    v_mul_f32 v62, v226, v62
    v_cvt_pk_bf16_f32 v168, v34, v38
    v_cvt_pk_bf16_f32 v169, v42, v46
    v_cvt_pk_bf16_f32 v170, v50, v54
    v_cvt_pk_bf16_f32 v171, v58, v62
    buffer_store_dwordx4 v[168:171], v251, s[20:23], s38 offen offset:512 sc0 sc1 nt
    s_waitcnt lgkmcnt(5)
    v_mul_f32 v35, v227, v35
    v_mul_f32 v39, v227, v39
    v_mul_f32 v43, v227, v43
    v_mul_f32 v47, v227, v47
    v_mul_f32 v51, v227, v51
    v_mul_f32 v55, v227, v55
    v_mul_f32 v59, v227, v59
    v_mul_f32 v63, v227, v63
    v_cvt_pk_bf16_f32 v172, v35, v39
    v_cvt_pk_bf16_f32 v173, v43, v47
    v_cvt_pk_bf16_f32 v174, v51, v55
    v_cvt_pk_bf16_f32 v175, v59, v63
    buffer_store_dwordx4 v[172:175], v251, s[20:23], s38 offen offset:768 sc0 sc1 nt
    s_waitcnt lgkmcnt(3)
    v_mul_f32 v64, v228, v64
    v_mul_f32 v68, v228, v68
    v_mul_f32 v72, v228, v72
    v_mul_f32 v76, v228, v76
    v_mul_f32 v80, v228, v80
    v_mul_f32 v84, v228, v84
    v_mul_f32 v88, v228, v88
    v_mul_f32 v92, v228, v92
    v_cvt_pk_bf16_f32 v144, v64, v68
    v_cvt_pk_bf16_f32 v145, v72, v76
    v_cvt_pk_bf16_f32 v146, v80, v84
    v_cvt_pk_bf16_f32 v147, v88, v92
    buffer_store_dwordx4 v[144:147], v251, s[20:23], s41 offen offset:0 sc0 sc1 nt
    s_waitcnt lgkmcnt(2)
    v_mul_f32 v65, v229, v65
    v_mul_f32 v69, v229, v69
    v_mul_f32 v73, v229, v73
    v_mul_f32 v77, v229, v77
    v_mul_f32 v81, v229, v81
    v_mul_f32 v85, v229, v85
    v_mul_f32 v89, v229, v89
    v_mul_f32 v93, v229, v93
    v_cvt_pk_bf16_f32 v148, v65, v69
    v_cvt_pk_bf16_f32 v149, v73, v77
    v_cvt_pk_bf16_f32 v150, v81, v85
    v_cvt_pk_bf16_f32 v151, v89, v93
    buffer_store_dwordx4 v[148:151], v251, s[20:23], s41 offen offset:256 sc0 sc1 nt
    s_waitcnt lgkmcnt(1)
    v_mul_f32 v66, v230, v66
    v_mul_f32 v70, v230, v70
    v_mul_f32 v74, v230, v74
    v_mul_f32 v78, v230, v78
    v_mul_f32 v82, v230, v82
    v_mul_f32 v86, v230, v86
    v_mul_f32 v90, v230, v90
    v_mul_f32 v94, v230, v94
    v_cvt_pk_bf16_f32 v152, v66, v70
    v_cvt_pk_bf16_f32 v153, v74, v78
    v_cvt_pk_bf16_f32 v154, v82, v86
    v_cvt_pk_bf16_f32 v155, v90, v94
    buffer_store_dwordx4 v[152:155], v251, s[20:23], s41 offen offset:512 sc0 sc1 nt
    s_waitcnt lgkmcnt(0)
    v_mul_f32 v67, v231, v67
    v_mul_f32 v71, v231, v71
    v_mul_f32 v75, v231, v75
    v_mul_f32 v79, v231, v79
    v_mul_f32 v83, v231, v83
    v_mul_f32 v87, v231, v87
    v_mul_f32 v91, v231, v91
    v_mul_f32 v95, v231, v95
    v_cvt_pk_bf16_f32 v156, v67, v71
    v_cvt_pk_bf16_f32 v157, v75, v79
    v_cvt_pk_bf16_f32 v158, v83, v87
    v_cvt_pk_bf16_f32 v159, v91, v95
    buffer_store_dwordx4 v[156:159], v251, s[20:23], s41 offen offset:768 sc0 sc1 nt
    s_cmp_lg_u64 vcc, 0
    s_cselect_b32 s32, 6, 0
    s_or_b32 s34, s34, s32
    s_mov_b64 vcc, 0
    s_sub_u32 s28, s28, 1
    s_cmp_eq_u32 s28, 0
    s_cbranch_scc1 L_exit
    v_mov_b32 v236, 0xff800000
    v_mov_b32 v237, 0xff800000
    s_waitcnt vmcnt(12)
    s_branch L_body2
L_start2:
    ds_read_b128 v[200:203], v244 offset:0
    ds_read_b128 v[204:207], v245 offset:1024
    ds_read_b128 v[208:211], v244 offset:2048
    ds_read_b128 v[212:215], v245 offset:3072
    ds_read_b128 v[216:219], v244 offset:4096
    s_waitcnt vmcnt(0)
L_body2:
    s_cmp_le_u32 s28, 1
    s_cselect_b32 s66, 0, 41943040
    ds_read_b128 v[192:195], v245 offset:5120
    ds_read_b128 v[196:199], v244 offset:6144
    ds_read_b128 v[228:231], v245 offset:7168
    s_setprio 3
    s_waitcnt lgkmcnt(4)
    v_mfma_f32_16x16x32_bf16 v[144:147], v[200:203], v[96:99], 0
    v_mfma_f32_16x16x32_bf16 v[144:147], v[204:207], v[100:103], v[144:147]
    v_mfma_f32_16x16x32_bf16 v[144:147], v[208:211], v[104:107], v[144:147]
    v_mfma_f32_16x16x32_bf16 v[144:147], v[212:215], v[108:111], v[144:147]
    v_mfma_f32_16x16x32_bf16 v[148:151], v[200:203], v[112:115], 0
    ds_read_b128 v[200:203], v244 offset:8192
    v_mfma_f32_16x16x32_bf16 v[148:151], v[204:207], v[116:119], v[148:151]
    ds_read_b128 v[204:207], v245 offset:9216
    v_mfma_f32_16x16x32_bf16 v[148:151], v[208:211], v[120:123], v[148:151]
    ds_read_b128 v[208:211], v244 offset:10240
    v_mfma_f32_16x16x32_bf16 v[148:151], v[212:215], v[124:127], v[148:151]
    ds_read_b128 v[212:215], v245 offset:11264
    s_waitcnt lgkmcnt(4)
    v_mfma_f32_16x16x32_bf16 v[152:155], v[216:219], v[96:99], 0
    v_mfma_f32_16x16x32_bf16 v[152:155], v[192:195], v[100:103], v[152:155]
    v_mfma_f32_16x16x32_bf16 v[152:155], v[196:199], v[104:107], v[152:155]
    v_mfma_f32_16x16x32_bf16 v[152:155], v[228:231], v[108:111], v[152:155]
    v_mfma_f32_16x16x32_bf16 v[156:159], v[216:219], v[112:115], 0
    ds_read_b128 v[216:219], v244 offset:12288
    v_mfma_f32_16x16x32_bf16 v[156:159], v[192:195], v[116:119], v[156:159]
    ds_read_b128 v[192:195], v245 offset:13312
    v_mfma_f32_16x16x32_bf16 v[156:159], v[196:199], v[120:123], v[156:159]
    ds_read_b128 v[196:199], v244 offset:14336
    v_mfma_f32_16x16x32_bf16 v[156:159], v[228:231], v[124:127], v[156:159]
    ds_read_b128 v[228:231], v245 offset:15360
    s_waitcnt lgkmcnt(4)
    s_setprio 0
    v_max3_f32 v232, v144, v145, v236
    v_max3_f32 v232, v146, v147, v232
    v_max3_f32 v233, v148, v149, v237
    v_max3_f32 v233, v150, v151, v233
    v_max3_f32 v232, v152, v153, v232
    v_max3_f32 v232, v154, v155, v232
    v_max3_f32 v233, v156, v157, v233
    v_max3_f32 v233, v158, v159, v233
    s_nop 1
    v_permlane32_swap_b32 v232, v233
    v_max_f32 v232, v232, v233
    v_mov_b32 v233, v232
    s_nop 1
    v_permlane16_swap_b32 v232, v233
    v_max_f32 v232, v232, v233
    v_sub_f32 v220, 0, v232
    v_sub_f32 v224, 0, v232
    s_nop 1
    v_permlane32_swap_b32 v220, v224
    v_mov_b32 v225, v224
    v_mov_b32 v226, v224
    v_mov_b32 v227, v224
    v_mov_b32 v221, v220
    v_mov_b32 v222, v220
    v_mov_b32 v223, v220
    s_setprio 3
    s_nop 0
    v_mfma_f32_16x16x32_bf16 v[160:163], v[200:203], v[96:99], v[220:223]
    v_mov_b32 v232, 0
    v_mov_b32 v233, 0
    v_mfma_f32_16x16x32_bf16 v[160:163], v[204:207], v[100:103], v[160:163]
    v_mov_b32 v234, 0
    v_mov_b32 v235, 0
    v_mfma_f32_16x16x32_bf16 v[160:163], v[208:211], v[104:107], v[160:163]
    v_add_f32 v144, v220, v144
    v_add_f32 v145, v220, v145
    v_mfma_f32_16x16x32_bf16 v[160:163], v[212:215], v[108:111], v[160:163]
    v_exp_f32 v144, v144
    v_mfma_f32_16x16x32_bf16 v[164:167], v[200:203], v[112:115], v[224:227]
    ds_read_b128 v[200:203], v248 offset:0
    v_add_f32 v146, v220, v146
    v_mfma_f32_16x16x32_bf16 v[164:167], v[204:207], v[116:119], v[164:167]
    ds_read_b128 v[204:207], v248 offset:1024
    v_add_f32 v147, v220, v147
    v_mfma_f32_16x16x32_bf16 v[164:167], v[208:211], v[120:123], v[164:167]
    ds_read_b128 v[208:211], v248 offset:2048
    v_add_f32 v148, v224, v148
    v_mfma_f32_16x16x32_bf16 v[164:167], v[212:215], v[124:127], v[164:167]
    ds_read_b128 v[212:215], v248 offset:3072
    s_waitcnt lgkmcnt(4)
    v_mfma_f32_16x16x32_bf16 v[168:171], v[216:219], v[96:99], v[220:223]
    v_exp_f32 v145, v145
    v_mfma_f32_16x16x32_bf16 v[168:171], v[192:195], v[100:103], v[168:171]
    v_exp_f32 v146, v146
    v_mfma_f32_16x16x32_bf16 v[168:171], v[196:199], v[104:107], v[168:171]
    v_exp_f32 v147, v147
    v_mfma_f32_16x16x32_bf16 v[168:171], v[228:231], v[108:111], v[168:171]
    v_exp_f32 v148, v148
    v_mfma_f32_16x16x32_bf16 v[172:175], v[216:219], v[112:115], v[224:227]
    ds_read_b128 v[216:219], v248 offset:4096
    v_cvt_pk_bf16_f32 v176, v144, v145
    v_mfma_f32_16x16x32_bf16 v[172:175], v[192:195], v[116:119], v[172:175]
    ds_read_b128 v[192:195], v248 offset:5120
    v_cvt_pk_bf16_f32 v177, v146, v147
    v_mfma_f32_16x16x32_bf16 v[172:175], v[196:199], v[120:123], v[172:175]
    ds_read_b128 v[196:199], v248 offset:6144
    v_add_f32 v149, v224, v149
    v_mfma_f32_16x16x32_bf16 v[172:175], v[228:231], v[124:127], v[172:175]
    ds_read_b128 v[228:231], v248 offset:7168
    s_waitcnt lgkmcnt(4)
    s_setprio 1
    v_exp_f32 v149, v149
    v_add_f32 v150, v224, v150
    v_cvt_pk_bf16_f32 v180, v148, v149
    v_exp_f32 v150, v150
    v_add_f32 v151, v224, v151
    v_exp_f32 v151, v151
    v_add_f32 v152, v220, v152
    v_cvt_pk_bf16_f32 v181, v150, v151
    v_exp_f32 v152, v152
    v_add_f32 v153, v220, v153
    v_exp_f32 v153, v153
    v_add_f32 v154, v220, v154
    v_cvt_pk_bf16_f32 v178, v152, v153
    v_exp_f32 v154, v154
    v_add_f32 v155, v220, v155
    v_exp_f32 v155, v155
    v_add_f32 v156, v224, v156
    v_cvt_pk_bf16_f32 v179, v154, v155
    v_exp_f32 v156, v156
    v_add_f32 v157, v224, v157
    v_exp_f32 v157, v157
    v_add_f32 v158, v224, v158
    v_cvt_pk_bf16_f32 v182, v156, v157
    v_exp_f32 v158, v158
    v_add_f32 v159, v224, v159
    v_exp_f32 v159, v159
    s_nop 0
    v_cvt_pk_bf16_f32 v183, v158, v159
    s_nop 1
    v_smfmac_f32_16x16x64_bf16 v[232:235], v[240:243], v[176:183], v252
    v_mfma_f32_16x16x32_bf16 v[0:3], v[176:179], v[200:203], 0
    v_exp_f32 v160, v160
    v_mfma_f32_16x16x32_bf16 v[32:35], v[180:183], v[200:203], 0
    ds_read_b128 v[200:203], v244 offset:16384
    v_mfma_f32_16x16x32_bf16 v[4:7], v[176:179], v[204:207], 0
    v_exp_f32 v161, v161
    v_mfma_f32_16x16x32_bf16 v[36:39], v[180:183], v[204:207], 0
    ds_read_b128 v[204:207], v245 offset:17408
    v_cvt_pk_bf16_f32 v184, v160, v161
    v_mfma_f32_16x16x32_bf16 v[8:11], v[176:179], v[208:211], 0
    v_exp_f32 v162, v162
    v_mfma_f32_16x16x32_bf16 v[40:43], v[180:183], v[208:211], 0
    ds_read_b128 v[208:211], v244 offset:18432
    v_mfma_f32_16x16x32_bf16 v[12:15], v[176:179], v[212:215], 0
    v_exp_f32 v163, v163
    v_mfma_f32_16x16x32_bf16 v[44:47], v[180:183], v[212:215], 0
    ds_read_b128 v[212:215], v245 offset:19456
    s_waitcnt lgkmcnt(4)
    v_mfma_f32_16x16x32_bf16 v[16:19], v[176:179], v[216:219], 0
    v_exp_f32 v164, v164
    v_mfma_f32_16x16x32_bf16 v[48:51], v[180:183], v[216:219], 0
    ds_read_b128 v[216:219], v244 offset:20480
    v_cvt_pk_bf16_f32 v185, v162, v163
    v_mfma_f32_16x16x32_bf16 v[20:23], v[176:179], v[192:195], 0
    v_exp_f32 v165, v165
    v_mfma_f32_16x16x32_bf16 v[52:55], v[180:183], v[192:195], 0
    ds_read_b128 v[192:195], v245 offset:21504
    v_cvt_pk_bf16_f32 v188, v164, v165
    v_mfma_f32_16x16x32_bf16 v[24:27], v[176:179], v[196:199], 0
    v_exp_f32 v166, v166
    v_mfma_f32_16x16x32_bf16 v[56:59], v[180:183], v[196:199], 0
    ds_read_b128 v[196:199], v244 offset:22528
    v_mfma_f32_16x16x32_bf16 v[28:31], v[176:179], v[228:231], 0
    v_exp_f32 v167, v167
    v_mfma_f32_16x16x32_bf16 v[60:63], v[180:183], v[228:231], 0
    ds_read_b128 v[228:231], v245 offset:23552
    s_waitcnt lgkmcnt(4)
    v_mfma_f32_16x16x32_bf16 v[144:147], v[200:203], v[96:99], v[220:223]
    v_exp_f32 v168, v168
    v_mfma_f32_16x16x32_bf16 v[144:147], v[204:207], v[100:103], v[144:147]
    v_exp_f32 v169, v169
    v_mfma_f32_16x16x32_bf16 v[144:147], v[208:211], v[104:107], v[144:147]
    v_exp_f32 v170, v170
    v_mfma_f32_16x16x32_bf16 v[144:147], v[212:215], v[108:111], v[144:147]
    v_exp_f32 v171, v171
    v_mfma_f32_16x16x32_bf16 v[148:151], v[200:203], v[112:115], v[224:227]
    ds_read_b128 v[200:203], v248 offset:8192
    v_cvt_pk_bf16_f32 v189, v166, v167
    v_mfma_f32_16x16x32_bf16 v[148:151], v[204:207], v[116:119], v[148:151]
    ds_read_b128 v[204:207], v248 offset:9216
    v_cvt_pk_bf16_f32 v186, v168, v169
    v_mfma_f32_16x16x32_bf16 v[148:151], v[208:211], v[120:123], v[148:151]
    ds_read_b128 v[208:211], v248 offset:10240
    v_cvt_pk_bf16_f32 v187, v170, v171
    v_mfma_f32_16x16x32_bf16 v[148:151], v[212:215], v[124:127], v[148:151]
    ds_read_b128 v[212:215], v248 offset:11264
    s_waitcnt lgkmcnt(4)
    v_mfma_f32_16x16x32_bf16 v[152:155], v[216:219], v[96:99], v[220:223]
    v_exp_f32 v172, v172
    v_mfma_f32_16x16x32_bf16 v[152:155], v[192:195], v[100:103], v[152:155]
    v_exp_f32 v173, v173
    v_mfma_f32_16x16x32_bf16 v[152:155], v[196:199], v[104:107], v[152:155]
    v_exp_f32 v174, v174
    v_mfma_f32_16x16x32_bf16 v[152:155], v[228:231], v[108:111], v[152:155]
    v_exp_f32 v175, v175
    v_mfma_f32_16x16x32_bf16 v[156:159], v[216:219], v[112:115], v[224:227]
    ds_read_b128 v[216:219], v248 offset:12288
    v_cvt_pk_bf16_f32 v190, v172, v173
    v_mfma_f32_16x16x32_bf16 v[156:159], v[192:195], v[116:119], v[156:159]
    ds_read_b128 v[192:195], v248 offset:13312
    v_cvt_pk_bf16_f32 v191, v174, v175
    v_mfma_f32_16x16x32_bf16 v[156:159], v[196:199], v[120:123], v[156:159]
    ds_read_b128 v[196:199], v248 offset:14336
    v_mfma_f32_16x16x32_bf16 v[156:159], v[228:231], v[124:127], v[156:159]
    ds_read_b128 v[228:231], v248 offset:15360
    s_waitcnt lgkmcnt(4)
    v_smfmac_f32_16x16x64_bf16 v[232:235], v[240:243], v[184:191], v252
    v_mfma_f32_16x16x32_bf16 v[0:3], v[184:187], v[200:203], v[0:3]
    v_exp_f32 v144, v144
    v_mfma_f32_16x16x32_bf16 v[32:35], v[188:191], v[200:203], v[32:35]
    ds_read_b128 v[200:203], v244 offset:24576
    v_mfma_f32_16x16x32_bf16 v[4:7], v[184:187], v[204:207], v[4:7]
    v_exp_f32 v145, v145
    v_mfma_f32_16x16x32_bf16 v[36:39], v[188:191], v[204:207], v[36:39]
    ds_read_b128 v[204:207], v245 offset:25600
    v_cvt_pk_bf16_f32 v176, v144, v145
    v_mfma_f32_16x16x32_bf16 v[8:11], v[184:187], v[208:211], v[8:11]
    v_exp_f32 v146, v146
    v_mfma_f32_16x16x32_bf16 v[40:43], v[188:191], v[208:211], v[40:43]
    ds_read_b128 v[208:211], v244 offset:26624
    v_mfma_f32_16x16x32_bf16 v[12:15], v[184:187], v[212:215], v[12:15]
    v_exp_f32 v147, v147
    v_mfma_f32_16x16x32_bf16 v[44:47], v[188:191], v[212:215], v[44:47]
    ds_read_b128 v[212:215], v245 offset:27648
    s_waitcnt lgkmcnt(4)
    v_mfma_f32_16x16x32_bf16 v[16:19], v[184:187], v[216:219], v[16:19]
    v_exp_f32 v148, v148
    v_mfma_f32_16x16x32_bf16 v[48:51], v[188:191], v[216:219], v[48:51]
    ds_read_b128 v[216:219], v244 offset:28672
    v_cvt_pk_bf16_f32 v177, v146, v147
    v_mfma_f32_16x16x32_bf16 v[20:23], v[184:187], v[192:195], v[20:23]
    v_exp_f32 v149, v149
    v_mfma_f32_16x16x32_bf16 v[52:55], v[188:191], v[192:195], v[52:55]
    ds_read_b128 v[192:195], v245 offset:29696
    v_cvt_pk_bf16_f32 v180, v148, v149
    v_mfma_f32_16x16x32_bf16 v[24:27], v[184:187], v[196:199], v[24:27]
    v_exp_f32 v150, v150
    v_mfma_f32_16x16x32_bf16 v[56:59], v[188:191], v[196:199], v[56:59]
    ds_read_b128 v[196:199], v244 offset:30720
    v_mfma_f32_16x16x32_bf16 v[28:31], v[184:187], v[228:231], v[28:31]
    v_exp_f32 v151, v151
    v_mfma_f32_16x16x32_bf16 v[60:63], v[188:191], v[228:231], v[60:63]
    ds_read_b128 v[228:231], v245 offset:31744
    s_waitcnt lgkmcnt(4)
    s_setprio 2
    v_mfma_f32_16x16x32_bf16 v[160:163], v[200:203], v[96:99], v[220:223]
    v_exp_f32 v152, v152
    v_mfma_f32_16x16x32_bf16 v[160:163], v[204:207], v[100:103], v[160:163]
    v_exp_f32 v153, v153
    v_mfma_f32_16x16x32_bf16 v[160:163], v[208:211], v[104:107], v[160:163]
    v_exp_f32 v154, v154
    v_mfma_f32_16x16x32_bf16 v[160:163], v[212:215], v[108:111], v[160:163]
    v_exp_f32 v155, v155
    v_mfma_f32_16x16x32_bf16 v[164:167], v[200:203], v[112:115], v[224:227]
    s_cbranch_vccnz L_bar2
L_barret2:
    ds_read_b128 v[200:203], v248 offset:16384
    v_cvt_pk_bf16_f32 v181, v150, v151
    v_mfma_f32_16x16x32_bf16 v[164:167], v[204:207], v[116:119], v[164:167]
    ds_read_b128 v[204:207], v248 offset:17408
    v_cvt_pk_bf16_f32 v178, v152, v153
    v_mfma_f32_16x16x32_bf16 v[164:167], v[208:211], v[120:123], v[164:167]
    ds_read_b128 v[208:211], v248 offset:18432
    v_cvt_pk_bf16_f32 v179, v154, v155
    v_mfma_f32_16x16x32_bf16 v[164:167], v[212:215], v[124:127], v[164:167]
    ds_read_b128 v[212:215], v248 offset:19456
    s_waitcnt lgkmcnt(4)
    v_mfma_f32_16x16x32_bf16 v[168:171], v[216:219], v[96:99], v[220:223]
    v_exp_f32 v156, v156
    v_mfma_f32_16x16x32_bf16 v[168:171], v[192:195], v[100:103], v[168:171]
    v_exp_f32 v157, v157
    v_mfma_f32_16x16x32_bf16 v[168:171], v[196:199], v[104:107], v[168:171]
    v_exp_f32 v158, v158
    v_mfma_f32_16x16x32_bf16 v[168:171], v[228:231], v[108:111], v[168:171]
    v_exp_f32 v159, v159
    v_mfma_f32_16x16x32_bf16 v[172:175], v[216:219], v[112:115], v[224:227]
    ds_read_b128 v[216:219], v248 offset:20480
    v_cvt_pk_bf16_f32 v182, v156, v157
    v_mfma_f32_16x16x32_bf16 v[172:175], v[192:195], v[116:119], v[172:175]
    ds_read_b128 v[192:195], v248 offset:21504
    v_cvt_pk_bf16_f32 v183, v158, v159
    v_mfma_f32_16x16x32_bf16 v[172:175], v[196:199], v[120:123], v[172:175]
    ds_read_b128 v[196:199], v248 offset:22528
    v_mfma_f32_16x16x32_bf16 v[172:175], v[228:231], v[124:127], v[172:175]
    ds_read_b128 v[228:231], v248 offset:23552
    s_waitcnt lgkmcnt(4)
    v_smfmac_f32_16x16x64_bf16 v[232:235], v[240:243], v[176:183], v252
    v_mfma_f32_16x16x32_bf16 v[0:3], v[176:179], v[200:203], v[0:3]
    v_exp_f32 v160, v160
    v_mfma_f32_16x16x32_bf16 v[32:35], v[180:183], v[200:203], v[32:35]
    ds_read_b128 v[200:203], v244 offset:32768
    v_mfma_f32_16x16x32_bf16 v[4:7], v[176:179], v[204:207], v[4:7]
    v_exp_f32 v161, v161
    v_mfma_f32_16x16x32_bf16 v[36:39], v[180:183], v[204:207], v[36:39]
    ds_read_b128 v[204:207], v245 offset:33792
    v_cvt_pk_bf16_f32 v184, v160, v161
    v_mfma_f32_16x16x32_bf16 v[8:11], v[176:179], v[208:211], v[8:11]
    v_exp_f32 v162, v162
    v_mfma_f32_16x16x32_bf16 v[40:43], v[180:183], v[208:211], v[40:43]
    ds_read_b128 v[208:211], v244 offset:34816
    v_mfma_f32_16x16x32_bf16 v[12:15], v[176:179], v[212:215], v[12:15]
    v_exp_f32 v163, v163
    v_mfma_f32_16x16x32_bf16 v[44:47], v[180:183], v[212:215], v[44:47]
    ds_read_b128 v[212:215], v245 offset:35840
    s_waitcnt lgkmcnt(4)
    v_mfma_f32_16x16x32_bf16 v[16:19], v[176:179], v[216:219], v[16:19]
    v_exp_f32 v164, v164
    v_mfma_f32_16x16x32_bf16 v[48:51], v[180:183], v[216:219], v[48:51]
    ds_read_b128 v[216:219], v244 offset:36864
    v_cvt_pk_bf16_f32 v185, v162, v163
    v_mfma_f32_16x16x32_bf16 v[20:23], v[176:179], v[192:195], v[20:23]
    v_exp_f32 v165, v165
    v_mfma_f32_16x16x32_bf16 v[52:55], v[180:183], v[192:195], v[52:55]
    ds_read_b128 v[192:195], v245 offset:37888
    v_cvt_pk_bf16_f32 v188, v164, v165
    v_mfma_f32_16x16x32_bf16 v[24:27], v[176:179], v[196:199], v[24:27]
    v_exp_f32 v166, v166
    v_mfma_f32_16x16x32_bf16 v[56:59], v[180:183], v[196:199], v[56:59]
    ds_read_b128 v[196:199], v244 offset:38912
    v_mfma_f32_16x16x32_bf16 v[28:31], v[176:179], v[228:231], v[28:31]
    v_exp_f32 v167, v167
    v_mfma_f32_16x16x32_bf16 v[60:63], v[180:183], v[228:231], v[60:63]
    ds_read_b128 v[228:231], v245 offset:39936
    s_waitcnt lgkmcnt(4)
    v_mfma_f32_16x16x32_bf16 v[144:147], v[200:203], v[96:99], v[220:223]
    v_exp_f32 v168, v168
    v_mfma_f32_16x16x32_bf16 v[144:147], v[204:207], v[100:103], v[144:147]
    v_exp_f32 v169, v169
    v_mfma_f32_16x16x32_bf16 v[144:147], v[208:211], v[104:107], v[144:147]
    v_exp_f32 v170, v170
    v_mfma_f32_16x16x32_bf16 v[144:147], v[212:215], v[108:111], v[144:147]
    v_exp_f32 v171, v171
    v_mfma_f32_16x16x32_bf16 v[148:151], v[200:203], v[112:115], v[224:227]
    ds_read_b128 v[200:203], v248 offset:24576
    v_cvt_pk_bf16_f32 v189, v166, v167
    v_mfma_f32_16x16x32_bf16 v[148:151], v[204:207], v[116:119], v[148:151]
    ds_read_b128 v[204:207], v248 offset:25600
    v_cvt_pk_bf16_f32 v186, v168, v169
    v_mfma_f32_16x16x32_bf16 v[148:151], v[208:211], v[120:123], v[148:151]
    ds_read_b128 v[208:211], v248 offset:26624
    v_cvt_pk_bf16_f32 v187, v170, v171
    v_mfma_f32_16x16x32_bf16 v[148:151], v[212:215], v[124:127], v[148:151]
    ds_read_b128 v[212:215], v248 offset:27648
    s_waitcnt lgkmcnt(4)
    v_mfma_f32_16x16x32_bf16 v[152:155], v[216:219], v[96:99], v[220:223]
    v_exp_f32 v172, v172
    v_mfma_f32_16x16x32_bf16 v[152:155], v[192:195], v[100:103], v[152:155]
    v_exp_f32 v173, v173
    v_mfma_f32_16x16x32_bf16 v[152:155], v[196:199], v[104:107], v[152:155]
    v_exp_f32 v174, v174
    v_mfma_f32_16x16x32_bf16 v[152:155], v[228:231], v[108:111], v[152:155]
    v_exp_f32 v175, v175
    v_mfma_f32_16x16x32_bf16 v[156:159], v[216:219], v[112:115], v[224:227]
    ds_read_b128 v[216:219], v248 offset:28672
    v_cvt_pk_bf16_f32 v190, v172, v173
    v_mfma_f32_16x16x32_bf16 v[156:159], v[192:195], v[116:119], v[156:159]
    ds_read_b128 v[192:195], v248 offset:29696
    v_cvt_pk_bf16_f32 v191, v174, v175
    v_mfma_f32_16x16x32_bf16 v[156:159], v[196:199], v[120:123], v[156:159]
    ds_read_b128 v[196:199], v248 offset:30720
    v_mfma_f32_16x16x32_bf16 v[156:159], v[228:231], v[124:127], v[156:159]
    ds_read_b128 v[228:231], v248 offset:31744
    s_waitcnt lgkmcnt(4)
    v_smfmac_f32_16x16x64_bf16 v[232:235], v[240:243], v[184:191], v252
    v_mfma_f32_16x16x32_bf16 v[0:3], v[184:187], v[200:203], v[0:3]
    v_exp_f32 v144, v144
    v_mfma_f32_16x16x32_bf16 v[32:35], v[188:191], v[200:203], v[32:35]
    ds_read_b128 v[200:203], v244 offset:40960
    v_mfma_f32_16x16x32_bf16 v[4:7], v[184:187], v[204:207], v[4:7]
    v_exp_f32 v145, v145
    v_mfma_f32_16x16x32_bf16 v[36:39], v[188:191], v[204:207], v[36:39]
    ds_read_b128 v[204:207], v245 offset:41984
    v_cvt_pk_bf16_f32 v176, v144, v145
    v_mfma_f32_16x16x32_bf16 v[8:11], v[184:187], v[208:211], v[8:11]
    v_exp_f32 v146, v146
    v_mfma_f32_16x16x32_bf16 v[40:43], v[188:191], v[208:211], v[40:43]
    ds_read_b128 v[208:211], v244 offset:43008
    v_mfma_f32_16x16x32_bf16 v[12:15], v[184:187], v[212:215], v[12:15]
    v_exp_f32 v147, v147
    v_mfma_f32_16x16x32_bf16 v[44:47], v[188:191], v[212:215], v[44:47]
    ds_read_b128 v[212:215], v245 offset:44032
    s_waitcnt lgkmcnt(4)
    v_mfma_f32_16x16x32_bf16 v[16:19], v[184:187], v[216:219], v[16:19]
    v_exp_f32 v148, v148
    v_mfma_f32_16x16x32_bf16 v[48:51], v[188:191], v[216:219], v[48:51]
    ds_read_b128 v[216:219], v244 offset:45056
    v_cvt_pk_bf16_f32 v177, v146, v147
    v_mfma_f32_16x16x32_bf16 v[20:23], v[184:187], v[192:195], v[20:23]
    v_exp_f32 v149, v149
    v_mfma_f32_16x16x32_bf16 v[52:55], v[188:191], v[192:195], v[52:55]
    ds_read_b128 v[192:195], v245 offset:46080
    v_cvt_pk_bf16_f32 v180, v148, v149
    v_mfma_f32_16x16x32_bf16 v[24:27], v[184:187], v[196:199], v[24:27]
    v_exp_f32 v150, v150
    v_mfma_f32_16x16x32_bf16 v[56:59], v[188:191], v[196:199], v[56:59]
    ds_read_b128 v[196:199], v244 offset:47104
    v_mfma_f32_16x16x32_bf16 v[28:31], v[184:187], v[228:231], v[28:31]
    v_exp_f32 v151, v151
    v_mfma_f32_16x16x32_bf16 v[60:63], v[188:191], v[228:231], v[60:63]
    ds_read_b128 v[228:231], v245 offset:48128
    s_waitcnt lgkmcnt(4)
    v_mfma_f32_16x16x32_bf16 v[160:163], v[200:203], v[96:99], v[220:223]
    v_exp_f32 v152, v152
    v_mfma_f32_16x16x32_bf16 v[160:163], v[204:207], v[100:103], v[160:163]
    v_exp_f32 v153, v153
    v_mfma_f32_16x16x32_bf16 v[160:163], v[208:211], v[104:107], v[160:163]
    v_exp_f32 v154, v154
    v_mfma_f32_16x16x32_bf16 v[160:163], v[212:215], v[108:111], v[160:163]
    v_exp_f32 v155, v155
    v_mfma_f32_16x16x32_bf16 v[164:167], v[200:203], v[112:115], v[224:227]
    s_cbranch_vccnz L_bar4
L_barret4:
    ds_read_b128 v[200:203], v248 offset:32768
    v_cvt_pk_bf16_f32 v181, v150, v151
    v_mfma_f32_16x16x32_bf16 v[164:167], v[204:207], v[116:119], v[164:167]
    ds_read_b128 v[204:207], v248 offset:33792
    v_cvt_pk_bf16_f32 v178, v152, v153
    v_mfma_f32_16x16x32_bf16 v[164:167], v[208:211], v[120:123], v[164:167]
    ds_read_b128 v[208:211], v248 offset:34816
    v_cvt_pk_bf16_f32 v179, v154, v155
    v_mfma_f32_16x16x32_bf16 v[164:167], v[212:215], v[124:127], v[164:167]
    ds_read_b128 v[212:215], v248 offset:35840
    s_waitcnt lgkmcnt(4)
    v_mfma_f32_16x16x32_bf16 v[168:171], v[216:219], v[96:99], v[220:223]
    v_exp_f32 v156, v156
    v_mfma_f32_16x16x32_bf16 v[168:171], v[192:195], v[100:103], v[168:171]
    v_exp_f32 v157, v157
    v_mfma_f32_16x16x32_bf16 v[168:171], v[196:199], v[104:107], v[168:171]
    v_exp_f32 v158, v158
    v_mfma_f32_16x16x32_bf16 v[168:171], v[228:231], v[108:111], v[168:171]
    v_exp_f32 v159, v159
    v_mfma_f32_16x16x32_bf16 v[172:175], v[216:219], v[112:115], v[224:227]
    ds_read_b128 v[216:219], v248 offset:36864
    v_cvt_pk_bf16_f32 v182, v156, v157
    v_mfma_f32_16x16x32_bf16 v[172:175], v[192:195], v[116:119], v[172:175]
    ds_read_b128 v[192:195], v248 offset:37888
    v_cvt_pk_bf16_f32 v183, v158, v159
    v_mfma_f32_16x16x32_bf16 v[172:175], v[196:199], v[120:123], v[172:175]
    ds_read_b128 v[196:199], v248 offset:38912
    v_mfma_f32_16x16x32_bf16 v[172:175], v[228:231], v[124:127], v[172:175]
    ds_read_b128 v[228:231], v248 offset:39936
    s_waitcnt lgkmcnt(4)
    v_smfmac_f32_16x16x64_bf16 v[232:235], v[240:243], v[176:183], v252
    v_mfma_f32_16x16x32_bf16 v[0:3], v[176:179], v[200:203], v[0:3]
    v_exp_f32 v160, v160
    v_mfma_f32_16x16x32_bf16 v[32:35], v[180:183], v[200:203], v[32:35]
    ds_read_b128 v[200:203], v244 offset:49152
    v_mfma_f32_16x16x32_bf16 v[4:7], v[176:179], v[204:207], v[4:7]
    v_exp_f32 v161, v161
    v_mfma_f32_16x16x32_bf16 v[36:39], v[180:183], v[204:207], v[36:39]
    ds_read_b128 v[204:207], v245 offset:50176
    v_cvt_pk_bf16_f32 v184, v160, v161
    v_mfma_f32_16x16x32_bf16 v[8:11], v[176:179], v[208:211], v[8:11]
    v_exp_f32 v162, v162
    v_mfma_f32_16x16x32_bf16 v[40:43], v[180:183], v[208:211], v[40:43]
    ds_read_b128 v[208:211], v244 offset:51200
    v_mfma_f32_16x16x32_bf16 v[12:15], v[176:179], v[212:215], v[12:15]
    v_exp_f32 v163, v163
    v_mfma_f32_16x16x32_bf16 v[44:47], v[180:183], v[212:215], v[44:47]
    ds_read_b128 v[212:215], v245 offset:52224
    s_waitcnt lgkmcnt(4)
    v_mfma_f32_16x16x32_bf16 v[16:19], v[176:179], v[216:219], v[16:19]
    v_exp_f32 v164, v164
    v_mfma_f32_16x16x32_bf16 v[48:51], v[180:183], v[216:219], v[48:51]
    ds_read_b128 v[216:219], v244 offset:53248
    v_cvt_pk_bf16_f32 v185, v162, v163
    v_mfma_f32_16x16x32_bf16 v[20:23], v[176:179], v[192:195], v[20:23]
    v_exp_f32 v165, v165
    v_mfma_f32_16x16x32_bf16 v[52:55], v[180:183], v[192:195], v[52:55]
    ds_read_b128 v[192:195], v245 offset:54272
    v_cvt_pk_bf16_f32 v188, v164, v165
    v_mfma_f32_16x16x32_bf16 v[24:27], v[176:179], v[196:199], v[24:27]
    v_exp_f32 v166, v166
    v_mfma_f32_16x16x32_bf16 v[56:59], v[180:183], v[196:199], v[56:59]
    ds_read_b128 v[196:199], v244 offset:55296
    v_mfma_f32_16x16x32_bf16 v[28:31], v[176:179], v[228:231], v[28:31]
    v_exp_f32 v167, v167
    v_mfma_f32_16x16x32_bf16 v[60:63], v[180:183], v[228:231], v[60:63]
    ds_read_b128 v[228:231], v245 offset:56320
    s_waitcnt lgkmcnt(4)
    v_mfma_f32_16x16x32_bf16 v[144:147], v[200:203], v[96:99], v[220:223]
    v_exp_f32 v168, v168
    v_mfma_f32_16x16x32_bf16 v[144:147], v[204:207], v[100:103], v[144:147]
    v_exp_f32 v169, v169
    v_mfma_f32_16x16x32_bf16 v[144:147], v[208:211], v[104:107], v[144:147]
    v_exp_f32 v170, v170
    v_mfma_f32_16x16x32_bf16 v[144:147], v[212:215], v[108:111], v[144:147]
    v_exp_f32 v171, v171
    v_mfma_f32_16x16x32_bf16 v[148:151], v[200:203], v[112:115], v[224:227]
    ds_read_b128 v[200:203], v248 offset:40960
    v_cvt_pk_bf16_f32 v189, v166, v167
    v_mfma_f32_16x16x32_bf16 v[148:151], v[204:207], v[116:119], v[148:151]
    ds_read_b128 v[204:207], v248 offset:41984
    v_cvt_pk_bf16_f32 v186, v168, v169
    v_mfma_f32_16x16x32_bf16 v[148:151], v[208:211], v[120:123], v[148:151]
    ds_read_b128 v[208:211], v248 offset:43008
    v_cvt_pk_bf16_f32 v187, v170, v171
    v_mfma_f32_16x16x32_bf16 v[148:151], v[212:215], v[124:127], v[148:151]
    ds_read_b128 v[212:215], v248 offset:44032
    s_waitcnt lgkmcnt(4)
    v_mfma_f32_16x16x32_bf16 v[152:155], v[216:219], v[96:99], v[220:223]
    v_exp_f32 v172, v172
    v_mfma_f32_16x16x32_bf16 v[152:155], v[192:195], v[100:103], v[152:155]
    v_exp_f32 v173, v173
    v_mfma_f32_16x16x32_bf16 v[152:155], v[196:199], v[104:107], v[152:155]
    v_exp_f32 v174, v174
    v_mfma_f32_16x16x32_bf16 v[152:155], v[228:231], v[108:111], v[152:155]
    v_exp_f32 v175, v175
    v_mfma_f32_16x16x32_bf16 v[156:159], v[216:219], v[112:115], v[224:227]
    ds_read_b128 v[216:219], v248 offset:45056
    v_cvt_pk_bf16_f32 v190, v172, v173
    v_mfma_f32_16x16x32_bf16 v[156:159], v[192:195], v[116:119], v[156:159]
    ds_read_b128 v[192:195], v248 offset:46080
    v_cvt_pk_bf16_f32 v191, v174, v175
    v_mfma_f32_16x16x32_bf16 v[156:159], v[196:199], v[120:123], v[156:159]
    ds_read_b128 v[196:199], v248 offset:47104
    v_mfma_f32_16x16x32_bf16 v[156:159], v[228:231], v[124:127], v[156:159]
    ds_read_b128 v[228:231], v248 offset:48128
    s_waitcnt lgkmcnt(4)
    v_smfmac_f32_16x16x64_bf16 v[232:235], v[240:243], v[184:191], v252
    v_mfma_f32_16x16x32_bf16 v[0:3], v[184:187], v[200:203], v[0:3]
    v_exp_f32 v144, v144
    v_mfma_f32_16x16x32_bf16 v[32:35], v[188:191], v[200:203], v[32:35]
    ds_read_b128 v[200:203], v244 offset:57344
    v_mfma_f32_16x16x32_bf16 v[4:7], v[184:187], v[204:207], v[4:7]
    v_exp_f32 v145, v145
    v_mfma_f32_16x16x32_bf16 v[36:39], v[188:191], v[204:207], v[36:39]
    ds_read_b128 v[204:207], v245 offset:58368
    v_cvt_pk_bf16_f32 v176, v144, v145
    v_mfma_f32_16x16x32_bf16 v[8:11], v[184:187], v[208:211], v[8:11]
    v_exp_f32 v146, v146
    v_mfma_f32_16x16x32_bf16 v[40:43], v[188:191], v[208:211], v[40:43]
    ds_read_b128 v[208:211], v244 offset:59392
    v_mfma_f32_16x16x32_bf16 v[12:15], v[184:187], v[212:215], v[12:15]
    v_exp_f32 v147, v147
    v_mfma_f32_16x16x32_bf16 v[44:47], v[188:191], v[212:215], v[44:47]
    ds_read_b128 v[212:215], v245 offset:60416
    s_waitcnt lgkmcnt(4)
    v_mfma_f32_16x16x32_bf16 v[16:19], v[184:187], v[216:219], v[16:19]
    v_exp_f32 v148, v148
    v_mfma_f32_16x16x32_bf16 v[48:51], v[188:191], v[216:219], v[48:51]
    ds_read_b128 v[216:219], v244 offset:61440
    v_cvt_pk_bf16_f32 v177, v146, v147
    v_mfma_f32_16x16x32_bf16 v[20:23], v[184:187], v[192:195], v[20:23]
    v_exp_f32 v149, v149
    v_mfma_f32_16x16x32_bf16 v[52:55], v[188:191], v[192:195], v[52:55]
    ds_read_b128 v[192:195], v245 offset:62464
    v_cvt_pk_bf16_f32 v180, v148, v149
    v_mfma_f32_16x16x32_bf16 v[24:27], v[184:187], v[196:199], v[24:27]
    v_exp_f32 v150, v150
    v_mfma_f32_16x16x32_bf16 v[56:59], v[188:191], v[196:199], v[56:59]
    ds_read_b128 v[196:199], v244 offset:63488
    v_mfma_f32_16x16x32_bf16 v[28:31], v[184:187], v[228:231], v[28:31]
    v_exp_f32 v151, v151
    v_mfma_f32_16x16x32_bf16 v[60:63], v[188:191], v[228:231], v[60:63]
    ds_read_b128 v[228:231], v245 offset:64512
    s_waitcnt lgkmcnt(4)
    v_mfma_f32_16x16x32_bf16 v[160:163], v[200:203], v[96:99], v[220:223]
    v_exp_f32 v152, v152
    v_mfma_f32_16x16x32_bf16 v[160:163], v[204:207], v[100:103], v[160:163]
    v_exp_f32 v153, v153
    v_mfma_f32_16x16x32_bf16 v[160:163], v[208:211], v[104:107], v[160:163]
    v_exp_f32 v154, v154
    v_mfma_f32_16x16x32_bf16 v[160:163], v[212:215], v[108:111], v[160:163]
    v_exp_f32 v155, v155
    v_mfma_f32_16x16x32_bf16 v[164:167], v[200:203], v[112:115], v[224:227]
    s_cbranch_vccnz L_bar6
L_barret6:
    ds_read_b128 v[200:203], v248 offset:49152
    v_cvt_pk_bf16_f32 v181, v150, v151
    v_mfma_f32_16x16x32_bf16 v[164:167], v[204:207], v[116:119], v[164:167]
    ds_read_b128 v[204:207], v248 offset:50176
    v_cvt_pk_bf16_f32 v178, v152, v153
    v_mfma_f32_16x16x32_bf16 v[164:167], v[208:211], v[120:123], v[164:167]
    ds_read_b128 v[208:211], v248 offset:51200
    v_cvt_pk_bf16_f32 v179, v154, v155
    v_mfma_f32_16x16x32_bf16 v[164:167], v[212:215], v[124:127], v[164:167]
    ds_read_b128 v[212:215], v248 offset:52224
    s_waitcnt lgkmcnt(4)
    v_mfma_f32_16x16x32_bf16 v[168:171], v[216:219], v[96:99], v[220:223]
    v_exp_f32 v156, v156
    v_mfma_f32_16x16x32_bf16 v[168:171], v[192:195], v[100:103], v[168:171]
    v_exp_f32 v157, v157
    v_mfma_f32_16x16x32_bf16 v[168:171], v[196:199], v[104:107], v[168:171]
    v_exp_f32 v158, v158
    v_mfma_f32_16x16x32_bf16 v[168:171], v[228:231], v[108:111], v[168:171]
    v_exp_f32 v159, v159
    v_mfma_f32_16x16x32_bf16 v[172:175], v[216:219], v[112:115], v[224:227]
    ds_read_b128 v[216:219], v248 offset:53248
    v_cvt_pk_bf16_f32 v182, v156, v157
    v_mfma_f32_16x16x32_bf16 v[172:175], v[192:195], v[116:119], v[172:175]
    ds_read_b128 v[192:195], v248 offset:54272
    v_cvt_pk_bf16_f32 v183, v158, v159
    v_mfma_f32_16x16x32_bf16 v[172:175], v[196:199], v[120:123], v[172:175]
    ds_read_b128 v[196:199], v248 offset:55296
    v_mfma_f32_16x16x32_bf16 v[172:175], v[228:231], v[124:127], v[172:175]
    ds_read_b128 v[228:231], v248 offset:56320
    s_waitcnt lgkmcnt(4)
    v_smfmac_f32_16x16x64_bf16 v[232:235], v[240:243], v[176:183], v252
    v_mfma_f32_16x16x32_bf16 v[0:3], v[176:179], v[200:203], v[0:3]
    v_exp_f32 v160, v160
    v_mfma_f32_16x16x32_bf16 v[32:35], v[180:183], v[200:203], v[32:35]
    ds_read_b128 v[200:203], v246 offset:0
    v_mfma_f32_16x16x32_bf16 v[4:7], v[176:179], v[204:207], v[4:7]
    v_exp_f32 v161, v161
    v_mfma_f32_16x16x32_bf16 v[36:39], v[180:183], v[204:207], v[36:39]
    ds_read_b128 v[204:207], v247 offset:1024
    v_cvt_pk_bf16_f32 v184, v160, v161
    v_mfma_f32_16x16x32_bf16 v[8:11], v[176:179], v[208:211], v[8:11]
    v_exp_f32 v162, v162
    v_mfma_f32_16x16x32_bf16 v[40:43], v[180:183], v[208:211], v[40:43]
    ds_read_b128 v[208:211], v246 offset:2048
    v_mfma_f32_16x16x32_bf16 v[12:15], v[176:179], v[212:215], v[12:15]
    v_exp_f32 v163, v163
    v_mfma_f32_16x16x32_bf16 v[44:47], v[180:183], v[212:215], v[44:47]
    ds_read_b128 v[212:215], v247 offset:3072
    s_waitcnt lgkmcnt(4)
    v_mfma_f32_16x16x32_bf16 v[16:19], v[176:179], v[216:219], v[16:19]
    v_exp_f32 v164, v164
    v_mfma_f32_16x16x32_bf16 v[48:51], v[180:183], v[216:219], v[48:51]
    ds_read_b128 v[216:219], v246 offset:4096
    v_cvt_pk_bf16_f32 v185, v162, v163
    v_mfma_f32_16x16x32_bf16 v[20:23], v[176:179], v[192:195], v[20:23]
    v_exp_f32 v165, v165
    v_mfma_f32_16x16x32_bf16 v[52:55], v[180:183], v[192:195], v[52:55]
    ds_read_b128 v[192:195], v247 offset:5120
    v_cvt_pk_bf16_f32 v188, v164, v165
    v_mfma_f32_16x16x32_bf16 v[24:27], v[176:179], v[196:199], v[24:27]
    v_exp_f32 v166, v166
    v_mfma_f32_16x16x32_bf16 v[56:59], v[180:183], v[196:199], v[56:59]
    ds_read_b128 v[196:199], v246 offset:6144
    v_mfma_f32_16x16x32_bf16 v[28:31], v[176:179], v[228:231], v[28:31]
    v_exp_f32 v167, v167
    v_mfma_f32_16x16x32_bf16 v[60:63], v[180:183], v[228:231], v[60:63]
    ds_read_b128 v[228:231], v247 offset:7168
    s_waitcnt lgkmcnt(4)
    s_setprio 3
    v_mfma_f32_16x16x32_bf16 v[144:147], v[200:203], v[96:99], v[220:223]
    v_exp_f32 v168, v168
    v_mfma_f32_16x16x32_bf16 v[144:147], v[204:207], v[100:103], v[144:147]
    v_exp_f32 v169, v169
    v_mfma_f32_16x16x32_bf16 v[144:147], v[208:211], v[104:107], v[144:147]
    v_exp_f32 v170, v170
    v_mfma_f32_16x16x32_bf16 v[144:147], v[212:215], v[108:111], v[144:147]
    v_exp_f32 v171, v171
    v_mfma_f32_16x16x32_bf16 v[148:151], v[200:203], v[112:115], v[224:227]
    ds_read_b128 v[200:203], v248 offset:57344
    v_cvt_pk_bf16_f32 v189, v166, v167
    v_mfma_f32_16x16x32_bf16 v[148:151], v[204:207], v[116:119], v[148:151]
    ds_read_b128 v[204:207], v248 offset:58368
    v_cvt_pk_bf16_f32 v186, v168, v169
    v_mfma_f32_16x16x32_bf16 v[148:151], v[208:211], v[120:123], v[148:151]
    ds_read_b128 v[208:211], v248 offset:59392
    v_cvt_pk_bf16_f32 v187, v170, v171
    v_mfma_f32_16x16x32_bf16 v[148:151], v[212:215], v[124:127], v[148:151]
    ds_read_b128 v[212:215], v248 offset:60416
    s_waitcnt lgkmcnt(4)
    v_mfma_f32_16x16x32_bf16 v[152:155], v[216:219], v[96:99], v[220:223]
    v_exp_f32 v172, v172
    v_mfma_f32_16x16x32_bf16 v[152:155], v[192:195], v[100:103], v[152:155]
    v_exp_f32 v173, v173
    v_mfma_f32_16x16x32_bf16 v[152:155], v[196:199], v[104:107], v[152:155]
    v_exp_f32 v174, v174
    v_mfma_f32_16x16x32_bf16 v[152:155], v[228:231], v[108:111], v[152:155]
    v_exp_f32 v175, v175
    v_mfma_f32_16x16x32_bf16 v[156:159], v[216:219], v[112:115], v[224:227]
    ds_read_b128 v[216:219], v248 offset:61440
    v_cvt_pk_bf16_f32 v190, v172, v173
    v_mfma_f32_16x16x32_bf16 v[156:159], v[192:195], v[116:119], v[156:159]
    ds_read_b128 v[192:195], v248 offset:62464
    v_cvt_pk_bf16_f32 v191, v174, v175
    v_mfma_f32_16x16x32_bf16 v[156:159], v[196:199], v[120:123], v[156:159]
    ds_read_b128 v[196:199], v248 offset:63488
    v_mfma_f32_16x16x32_bf16 v[156:159], v[228:231], v[124:127], v[156:159]
    ds_read_b128 v[228:231], v248 offset:64512
    s_waitcnt lgkmcnt(4)
    v_smfmac_f32_16x16x64_bf16 v[232:235], v[240:243], v[184:191], v252
    v_mfma_f32_16x16x32_bf16 v[0:3], v[184:187], v[200:203], v[0:3]
    v_exp_f32 v144, v144
    v_mfma_f32_16x16x32_bf16 v[32:35], v[188:191], v[200:203], v[32:35]
    ds_read_b128 v[200:203], v246 offset:8192
    v_mfma_f32_16x16x32_bf16 v[4:7], v[184:187], v[204:207], v[4:7]
    v_exp_f32 v145, v145
    v_mfma_f32_16x16x32_bf16 v[36:39], v[188:191], v[204:207], v[36:39]
    ds_read_b128 v[204:207], v247 offset:9216
    v_cvt_pk_bf16_f32 v176, v144, v145
    v_mfma_f32_16x16x32_bf16 v[8:11], v[184:187], v[208:211], v[8:11]
    v_exp_f32 v146, v146
    v_mfma_f32_16x16x32_bf16 v[40:43], v[188:191], v[208:211], v[40:43]
    ds_read_b128 v[208:211], v246 offset:10240
    v_mfma_f32_16x16x32_bf16 v[12:15], v[184:187], v[212:215], v[12:15]
    v_exp_f32 v147, v147
    v_mfma_f32_16x16x32_bf16 v[44:47], v[188:191], v[212:215], v[44:47]
    ds_read_b128 v[212:215], v247 offset:11264
    s_waitcnt lgkmcnt(4)
    v_mfma_f32_16x16x32_bf16 v[16:19], v[184:187], v[216:219], v[16:19]
    v_exp_f32 v148, v148
    v_mfma_f32_16x16x32_bf16 v[48:51], v[188:191], v[216:219], v[48:51]
    ds_read_b128 v[216:219], v246 offset:12288
    v_cvt_pk_bf16_f32 v177, v146, v147
    v_mfma_f32_16x16x32_bf16 v[20:23], v[184:187], v[192:195], v[20:23]
    v_exp_f32 v149, v149
    v_mfma_f32_16x16x32_bf16 v[52:55], v[188:191], v[192:195], v[52:55]
    ds_read_b128 v[192:195], v247 offset:13312
    v_cvt_pk_bf16_f32 v180, v148, v149
    v_mfma_f32_16x16x32_bf16 v[24:27], v[184:187], v[196:199], v[24:27]
    v_exp_f32 v150, v150
    v_mfma_f32_16x16x32_bf16 v[56:59], v[188:191], v[196:199], v[56:59]
    ds_read_b128 v[196:199], v246 offset:14336
    v_mfma_f32_16x16x32_bf16 v[28:31], v[184:187], v[228:231], v[28:31]
    v_exp_f32 v151, v151
    v_mfma_f32_16x16x32_bf16 v[60:63], v[188:191], v[228:231], v[60:63]
    ds_read_b128 v[228:231], v247 offset:15360
    s_waitcnt lgkmcnt(4)
    v_mfma_f32_16x16x32_bf16 v[160:163], v[200:203], v[96:99], v[220:223]
    v_exp_f32 v152, v152
    v_mfma_f32_16x16x32_bf16 v[160:163], v[204:207], v[100:103], v[160:163]
    v_exp_f32 v153, v153
    v_mfma_f32_16x16x32_bf16 v[160:163], v[208:211], v[104:107], v[160:163]
    v_exp_f32 v154, v154
    v_mfma_f32_16x16x32_bf16 v[160:163], v[212:215], v[108:111], v[160:163]
    v_exp_f32 v155, v155
    v_mfma_f32_16x16x32_bf16 v[164:167], v[200:203], v[112:115], v[224:227]
    ds_read_b128 v[200:203], v249 offset:0
    v_cvt_pk_bf16_f32 v181, v150, v151
    v_mfma_f32_16x16x32_bf16 v[164:167], v[204:207], v[116:119], v[164:167]
    ds_read_b128 v[204:207], v249 offset:1024
    v_cvt_pk_bf16_f32 v178, v152, v153
    v_mfma_f32_16x16x32_bf16 v[164:167], v[208:211], v[120:123], v[164:167]
    ds_read_b128 v[208:211], v249 offset:2048
    v_cvt_pk_bf16_f32 v179, v154, v155
    v_mfma_f32_16x16x32_bf16 v[164:167], v[212:215], v[124:127], v[164:167]
    ds_read_b128 v[212:215], v249 offset:3072
    s_waitcnt lgkmcnt(4)
    v_mfma_f32_16x16x32_bf16 v[168:171], v[216:219], v[96:99], v[220:223]
    v_exp_f32 v156, v156
    v_mfma_f32_16x16x32_bf16 v[168:171], v[192:195], v[100:103], v[168:171]
    v_exp_f32 v157, v157
    v_mfma_f32_16x16x32_bf16 v[168:171], v[196:199], v[104:107], v[168:171]
    v_exp_f32 v158, v158
    v_mfma_f32_16x16x32_bf16 v[168:171], v[228:231], v[108:111], v[168:171]
    v_exp_f32 v159, v159
    v_mfma_f32_16x16x32_bf16 v[172:175], v[216:219], v[112:115], v[224:227]
    ds_read_b128 v[216:219], v249 offset:4096
    v_cvt_pk_bf16_f32 v182, v156, v157
    v_mfma_f32_16x16x32_bf16 v[172:175], v[192:195], v[116:119], v[172:175]
    ds_read_b128 v[192:195], v249 offset:5120
    v_cvt_pk_bf16_f32 v183, v158, v159
    v_mfma_f32_16x16x32_bf16 v[172:175], v[196:199], v[120:123], v[172:175]
    ds_read_b128 v[196:199], v249 offset:6144
    v_mfma_f32_16x16x32_bf16 v[172:175], v[228:231], v[124:127], v[172:175]
    ds_read_b128 v[228:231], v249 offset:7168
    s_waitcnt lgkmcnt(4)
    v_smfmac_f32_16x16x64_bf16 v[232:235], v[240:243], v[176:183], v252
    v_mfma_f32_16x16x32_bf16 v[0:3], v[176:179], v[200:203], v[0:3]
    v_exp_f32 v160, v160
    v_mfma_f32_16x16x32_bf16 v[32:35], v[180:183], v[200:203], v[32:35]
    ds_read_b128 v[200:203], v249 offset:8192
    v_mfma_f32_16x16x32_bf16 v[4:7], v[176:179], v[204:207], v[4:7]
    v_exp_f32 v161, v161
    v_mfma_f32_16x16x32_bf16 v[36:39], v[180:183], v[204:207], v[36:39]
    ds_read_b128 v[204:207], v249 offset:9216
    v_cvt_pk_bf16_f32 v184, v160, v161
    v_mfma_f32_16x16x32_bf16 v[8:11], v[176:179], v[208:211], v[8:11]
    v_exp_f32 v162, v162
    v_mfma_f32_16x16x32_bf16 v[40:43], v[180:183], v[208:211], v[40:43]
    ds_read_b128 v[208:211], v249 offset:10240
    v_mfma_f32_16x16x32_bf16 v[12:15], v[176:179], v[212:215], v[12:15]
    v_exp_f32 v163, v163
    v_mfma_f32_16x16x32_bf16 v[44:47], v[180:183], v[212:215], v[44:47]
    ds_read_b128 v[212:215], v249 offset:11264
    s_waitcnt lgkmcnt(4)
    v_mfma_f32_16x16x32_bf16 v[16:19], v[176:179], v[216:219], v[16:19]
    v_exp_f32 v164, v164
    v_mfma_f32_16x16x32_bf16 v[48:51], v[180:183], v[216:219], v[48:51]
    ds_read_b128 v[216:219], v249 offset:12288
    v_cvt_pk_bf16_f32 v185, v162, v163
    v_mfma_f32_16x16x32_bf16 v[20:23], v[176:179], v[192:195], v[20:23]
    v_exp_f32 v165, v165
    v_mfma_f32_16x16x32_bf16 v[52:55], v[180:183], v[192:195], v[52:55]
    ds_read_b128 v[192:195], v249 offset:13312
    v_cvt_pk_bf16_f32 v188, v164, v165
    v_mfma_f32_16x16x32_bf16 v[24:27], v[176:179], v[196:199], v[24:27]
    v_exp_f32 v166, v166
    v_mfma_f32_16x16x32_bf16 v[56:59], v[180:183], v[196:199], v[56:59]
    ds_read_b128 v[196:199], v249 offset:14336
    v_mfma_f32_16x16x32_bf16 v[28:31], v[176:179], v[228:231], v[28:31]
    v_exp_f32 v167, v167
    v_mfma_f32_16x16x32_bf16 v[60:63], v[180:183], v[228:231], v[60:63]
    ds_read_b128 v[228:231], v249 offset:15360
    s_waitcnt lgkmcnt(4)
    v_cvt_pk_bf16_f32 v189, v166, v167
    v_exp_f32 v168, v168
    v_exp_f32 v169, v169
    v_exp_f32 v170, v170
    v_cvt_pk_bf16_f32 v186, v168, v169
    v_exp_f32 v171, v171
    v_exp_f32 v172, v172
    v_cvt_pk_bf16_f32 v187, v170, v171
    v_exp_f32 v173, v173
    v_exp_f32 v174, v174
    v_cvt_pk_bf16_f32 v190, v172, v173
    v_exp_f32 v175, v175
    s_nop 0
    v_cvt_pk_bf16_f32 v191, v174, v175
    s_nop 1
    v_smfmac_f32_16x16x64_bf16 v[232:235], v[240:243], v[184:191], v252
    v_mfma_f32_16x16x32_bf16 v[0:3], v[184:187], v[200:203], v[0:3]
    v_mfma_f32_16x16x32_bf16 v[32:35], v[188:191], v[200:203], v[32:35]
    ds_read_b128 v[200:203], v244 offset:0
    v_mfma_f32_16x16x32_bf16 v[4:7], v[184:187], v[204:207], v[4:7]
    v_mfma_f32_16x16x32_bf16 v[36:39], v[188:191], v[204:207], v[36:39]
    ds_read_b128 v[204:207], v245 offset:1024
    v_mfma_f32_16x16x32_bf16 v[8:11], v[184:187], v[208:211], v[8:11]
    v_mfma_f32_16x16x32_bf16 v[40:43], v[188:191], v[208:211], v[40:43]
    ds_read_b128 v[208:211], v244 offset:2048
    v_add_f32 v232, v232, v233
    v_mfma_f32_16x16x32_bf16 v[12:15], v[184:187], v[212:215], v[12:15]
    v_rcp_f32 v233, v232
    v_mfma_f32_16x16x32_bf16 v[44:47], v[188:191], v[212:215], v[44:47]
    ds_read_b128 v[212:215], v245 offset:3072
    s_waitcnt lgkmcnt(4)
    v_add_f32 v234, v234, v235
    v_rcp_f32 v235, v234
    v_add_f32 v176, v232, v234
    v_cmp_nge_f32 vcc, s40, v176
    v_mfma_f32_16x16x32_bf16 v[16:19], v[184:187], v[216:219], v[16:19]
    ds_bpermute_b32 v220, v253, v233 offset:0
    v_mfma_f32_16x16x32_bf16 v[48:51], v[188:191], v[216:219], v[48:51]
    ds_read_b128 v[216:219], v244 offset:4096
    v_mfma_f32_16x16x32_bf16 v[20:23], v[184:187], v[192:195], v[20:23]
    ds_bpermute_b32 v221, v253, v233 offset:4
    v_mfma_f32_16x16x32_bf16 v[52:55], v[188:191], v[192:195], v[52:55]
    ds_bpermute_b32 v222, v253, v233 offset:8
    v_mfma_f32_16x16x32_bf16 v[24:27], v[184:187], v[196:199], v[24:27]
    ds_bpermute_b32 v223, v253, v233 offset:12
    v_mfma_f32_16x16x32_bf16 v[56:59], v[188:191], v[196:199], v[56:59]
    ds_bpermute_b32 v224, v253, v235 offset:0
    v_mfma_f32_16x16x32_bf16 v[28:31], v[184:187], v[228:231], v[28:31]
    ds_bpermute_b32 v225, v253, v235 offset:4
    v_mfma_f32_16x16x32_bf16 v[60:63], v[188:191], v[228:231], v[60:63]
    ds_bpermute_b32 v226, v253, v235 offset:8
    s_waitcnt lgkmcnt(8)
    ds_bpermute_b32 v227, v253, v235 offset:12
    s_setprio 0
    s_cmp_le_u32 s28, 1
    s_cbranch_scc1 L_nq2
    buffer_load_dwordx4 v[96:99], v250, s[8:11], s37 offen offset:0 nt
    buffer_load_dwordx4 v[100:103], v250, s[8:11], s37 offen offset:64 nt
    buffer_load_dwordx4 v[112:115], v250, s[8:11], s38 offen offset:0 nt
    buffer_load_dwordx4 v[116:119], v250, s[8:11], s38 offen offset:64 nt
    buffer_load_dwordx4 v[128:131], v250, s[8:11], s41 offen offset:0 nt
    buffer_load_dwordx4 v[132:135], v250, s[8:11], s41 offen offset:64 nt
    buffer_load_dwordx4 v[104:107], v250, s[8:11], s37 offen offset:128 nt
    buffer_load_dwordx4 v[108:111], v250, s[8:11], s37 offen offset:192 nt
    buffer_load_dwordx4 v[120:123], v250, s[8:11], s38 offen offset:128 nt
    buffer_load_dwordx4 v[124:127], v250, s[8:11], s38 offen offset:192 nt
    buffer_load_dwordx4 v[136:139], v250, s[8:11], s41 offen offset:128 nt
    buffer_load_dwordx4 v[140:143], v250, s[8:11], s41 offen offset:192 nt
L_nq2:
    s_waitcnt lgkmcnt(8)
    v_mul_f32 v0, v220, v0
    v_mul_f32 v4, v220, v4
    v_mul_f32 v8, v220, v8
    v_mul_f32 v12, v220, v12
    v_mul_f32 v16, v220, v16
    v_mul_f32 v20, v220, v20
    v_mul_f32 v24, v220, v24
    v_mul_f32 v28, v220, v28
    v_cvt_pk_bf16_f32 v144, v0, v4
    v_cvt_pk_bf16_f32 v145, v8, v12
    v_cvt_pk_bf16_f32 v146, v16, v20
    v_cvt_pk_bf16_f32 v147, v24, v28
    buffer_store_dwordx4 v[144:147], v251, s[20:23], s26 offen offset:0 sc0 sc1 nt
    s_waitcnt lgkmcnt(6)
    v_mul_f32 v1, v221, v1
    v_mul_f32 v5, v221, v5
    v_mul_f32 v9, v221, v9
    v_mul_f32 v13, v221, v13
    v_mul_f32 v17, v221, v17
    v_mul_f32 v21, v221, v21
    v_mul_f32 v25, v221, v25
    v_mul_f32 v29, v221, v29
    v_cvt_pk_bf16_f32 v148, v1, v5
    v_cvt_pk_bf16_f32 v149, v9, v13
    v_cvt_pk_bf16_f32 v150, v17, v21
    v_cvt_pk_bf16_f32 v151, v25, v29
    buffer_store_dwordx4 v[148:151], v251, s[20:23], s26 offen offset:256 sc0 sc1 nt
    s_waitcnt lgkmcnt(5)
    v_mul_f32 v2, v222, v2
    v_mul_f32 v6, v222, v6
    v_mul_f32 v10, v222, v10
    v_mul_f32 v14, v222, v14
    v_mul_f32 v18, v222, v18
    v_mul_f32 v22, v222, v22
    v_mul_f32 v26, v222, v26
    v_mul_f32 v30, v222, v30
    v_cvt_pk_bf16_f32 v152, v2, v6
    v_cvt_pk_bf16_f32 v153, v10, v14
    v_cvt_pk_bf16_f32 v154, v18, v22
    v_cvt_pk_bf16_f32 v155, v26, v30
    buffer_store_dwordx4 v[152:155], v251, s[20:23], s26 offen offset:512 sc0 sc1 nt
    s_waitcnt lgkmcnt(4)
    v_mul_f32 v3, v223, v3
    v_mul_f32 v7, v223, v7
    v_mul_f32 v11, v223, v11
    v_mul_f32 v15, v223, v15
    v_mul_f32 v19, v223, v19
    v_mul_f32 v23, v223, v23
    v_mul_f32 v27, v223, v27
    v_mul_f32 v31, v223, v31
    v_cvt_pk_bf16_f32 v156, v3, v7
    v_cvt_pk_bf16_f32 v157, v11, v15
    v_cvt_pk_bf16_f32 v158, v19, v23
    v_cvt_pk_bf16_f32 v159, v27, v31
    buffer_store_dwordx4 v[156:159], v251, s[20:23], s26 offen offset:768 sc0 sc1 nt
    s_waitcnt lgkmcnt(3)
    v_mul_f32 v32, v224, v32
    v_mul_f32 v36, v224, v36
    v_mul_f32 v40, v224, v40
    v_mul_f32 v44, v224, v44
    v_mul_f32 v48, v224, v48
    v_mul_f32 v52, v224, v52
    v_mul_f32 v56, v224, v56
    v_mul_f32 v60, v224, v60
    v_cvt_pk_bf16_f32 v160, v32, v36
    v_cvt_pk_bf16_f32 v161, v40, v44
    v_cvt_pk_bf16_f32 v162, v48, v52
    v_cvt_pk_bf16_f32 v163, v56, v60
    buffer_store_dwordx4 v[160:163], v251, s[20:23], s27 offen offset:0 sc0 sc1 nt
    s_waitcnt lgkmcnt(2)
    v_mul_f32 v33, v225, v33
    v_mul_f32 v37, v225, v37
    v_mul_f32 v41, v225, v41
    v_mul_f32 v45, v225, v45
    v_mul_f32 v49, v225, v49
    v_mul_f32 v53, v225, v53
    v_mul_f32 v57, v225, v57
    v_mul_f32 v61, v225, v61
    v_cvt_pk_bf16_f32 v164, v33, v37
    v_cvt_pk_bf16_f32 v165, v41, v45
    v_cvt_pk_bf16_f32 v166, v49, v53
    v_cvt_pk_bf16_f32 v167, v57, v61
    buffer_store_dwordx4 v[164:167], v251, s[20:23], s27 offen offset:256 sc0 sc1 nt
    s_waitcnt lgkmcnt(1)
    v_mul_f32 v34, v226, v34
    v_mul_f32 v38, v226, v38
    v_mul_f32 v42, v226, v42
    v_mul_f32 v46, v226, v46
    v_mul_f32 v50, v226, v50
    v_mul_f32 v54, v226, v54
    v_mul_f32 v58, v226, v58
    v_mul_f32 v62, v226, v62
    v_cvt_pk_bf16_f32 v168, v34, v38
    v_cvt_pk_bf16_f32 v169, v42, v46
    v_cvt_pk_bf16_f32 v170, v50, v54
    v_cvt_pk_bf16_f32 v171, v58, v62
    buffer_store_dwordx4 v[168:171], v251, s[20:23], s27 offen offset:512 sc0 sc1 nt
    s_waitcnt lgkmcnt(0)
    v_mul_f32 v35, v227, v35
    v_mul_f32 v39, v227, v39
    v_mul_f32 v43, v227, v43
    v_mul_f32 v47, v227, v47
    v_mul_f32 v51, v227, v51
    v_mul_f32 v55, v227, v55
    v_mul_f32 v59, v227, v59
    v_mul_f32 v63, v227, v63
    v_cvt_pk_bf16_f32 v172, v35, v39
    v_cvt_pk_bf16_f32 v173, v43, v47
    v_cvt_pk_bf16_f32 v174, v51, v55
    v_cvt_pk_bf16_f32 v175, v59, v63
    buffer_store_dwordx4 v[172:175], v251, s[20:23], s27 offen offset:768 sc0 sc1 nt
    s_cmp_lg_u64 vcc, 0
    s_cselect_b32 s32, 1, 0
    s_or_b32 s34, s34, s32
    s_mov_b64 vcc, 0
    s_sub_u32 s28, s28, 1
    s_cmp_eq_u32 s28, 0
    s_cbranch_scc1 L_exit
    s_waitcnt vmcnt(8)
    s_branch L_body3
L_exit:
    s_cmp_lg_u32 s36, 0
    s_cselect_b32 s34, s36, s34
    s_and_b32 s34, s34, 7
    s_cmp_eq_u32 s34, 0
    s_cbranch_scc1 L_done
    s_ff1_i32_b32 s32, s34
    s_bitset0_b32 s34, s32
    s_or_b32 s36, s34, 8
    s_cmp_eq_u32 s32, 1
    s_cselect_b32 s33, s37, s38
    s_cmp_eq_u32 s32, 0
    s_cselect_b32 s26, s39, s33
    s_add_u32 s27, s26, 4096
    s_mov_b32 s28, 1
    s_waitcnt vmcnt(0) lgkmcnt(0)
    buffer_load_dwordx4 v[96:99], v250, s[8:11], s26 offen offset:0 nt
    buffer_load_dwordx4 v[100:103], v250, s[8:11], s26 offen offset:64 nt
    buffer_load_dwordx4 v[112:115], v250, s[8:11], s27 offen offset:0 nt
    buffer_load_dwordx4 v[116:119], v250, s[8:11], s27 offen offset:64 nt
    buffer_load_dwordx4 v[104:107], v250, s[8:11], s26 offen offset:128 nt
    buffer_load_dwordx4 v[108:111], v250, s[8:11], s26 offen offset:192 nt
    buffer_load_dwordx4 v[120:123], v250, s[8:11], s27 offen offset:128 nt
    buffer_load_dwordx4 v[124:127], v250, s[8:11], s27 offen offset:192 nt
    v_mov_b32 v236, 0xff800000
    v_mov_b32 v237, 0xff800000
    v_mov_b32 v232, v244
    v_mov_b32 v233, v245
    s_mov_b32 s35, 0
    s_waitcnt vmcnt(0)
L_pre:
    ds_read_b128 v[0:3], v232 offset:0
    ds_read_b128 v[4:7], v233 offset:1024
    ds_read_b128 v[8:11], v232 offset:2048
    ds_read_b128 v[12:15], v233 offset:3072
    ds_read_b128 v[16:19], v232 offset:4096
    ds_read_b128 v[20:23], v233 offset:5120
    ds_read_b128 v[24:27], v232 offset:6144
    ds_read_b128 v[28:31], v233 offset:7168
    s_waitcnt lgkmcnt(0)
    v_mfma_f32_16x16x32_bf16 v[144:147], v[0:3], v[96:99], 0
    v_mfma_f32_16x16x32_bf16 v[152:155], v[0:3], v[112:115], 0
    v_mfma_f32_16x16x32_bf16 v[144:147], v[4:7], v[100:103], v[144:147]
    v_mfma_f32_16x16x32_bf16 v[152:155], v[4:7], v[116:119], v[152:155]
    v_mfma_f32_16x16x32_bf16 v[144:147], v[8:11], v[104:107], v[144:147]
    v_mfma_f32_16x16x32_bf16 v[152:155], v[8:11], v[120:123], v[152:155]
    v_mfma_f32_16x16x32_bf16 v[144:147], v[12:15], v[108:111], v[144:147]
    v_mfma_f32_16x16x32_bf16 v[152:155], v[12:15], v[124:127], v[152:155]
    v_mfma_f32_16x16x32_bf16 v[148:151], v[16:19], v[96:99], 0
    v_mfma_f32_16x16x32_bf16 v[156:159], v[16:19], v[112:115], 0
    v_mfma_f32_16x16x32_bf16 v[148:151], v[20:23], v[100:103], v[148:151]
    v_mfma_f32_16x16x32_bf16 v[156:159], v[20:23], v[116:119], v[156:159]
    v_mfma_f32_16x16x32_bf16 v[148:151], v[24:27], v[104:107], v[148:151]
    v_mfma_f32_16x16x32_bf16 v[156:159], v[24:27], v[120:123], v[156:159]
    v_mfma_f32_16x16x32_bf16 v[148:151], v[28:31], v[108:111], v[148:151]
    v_mfma_f32_16x16x32_bf16 v[156:159], v[28:31], v[124:127], v[156:159]
    v_add_u32 v232, 0x2000, v232
    v_add_u32 v233, 0x2000, v233
    v_max3_f32 v236, v144, v145, v236
    v_max3_f32 v236, v146, v147, v236
    s_nop 2
    v_max3_f32 v236, v148, v149, v236
    v_max3_f32 v236, v150, v151, v236
    v_max3_f32 v237, v152, v153, v237
    v_max3_f32 v237, v154, v155, v237
    v_max3_f32 v237, v156, v157, v237
    v_max3_f32 v237, v158, v159, v237
    s_add_u32 s35, s35, 1
    s_cmp_lt_u32 s35, 10
    s_nop 7
    s_cbranch_scc1 L_pre
    s_branch L_start2
L_bar2:
    s_barrier
    s_branch L_barret2
L_bar4:
    s_barrier
    s_branch L_barret4
L_bar6:
    s_barrier
    s_branch L_barret6
L_done:
L_end:
s_endpgm
.section .rodata,"a"
.p2align 6
.amdhsa_kernel standalone__gqa_softmax__near_ridge_kernel
  .amdhsa_next_free_vgpr 256
  .amdhsa_next_free_sgpr 100
  .amdhsa_accum_offset 256
  .amdhsa_group_segment_fixed_size 0
  .amdhsa_kernarg_size 48
  .amdhsa_user_sgpr_count 2
  .amdhsa_user_sgpr_kernarg_segment_ptr 1
  .amdhsa_system_sgpr_workgroup_id_x 1
.end_amdhsa_kernel
```
